```python
import torch

def _softmax(x, axis=-1):
    return torch.softmax(x, dim=axis)
def _gelu(x):
    return torch.nn.functional.gelu(x, approximate="tanh")
def _silu(x):
    return torch.nn.functional.silu(x)
def _sigmoid(x):
    return torch.sigmoid(x)
def _layernorm(x, axis=-1, eps=1e-5):
    m = x.mean(dim=axis, keepdim=True)
    v = x.var(dim=axis, keepdim=True, unbiased=False)
    return (x - m) / torch.sqrt(v + eps)
def _scatter_add(tgt, idx, src, axis=0):
    return tgt.clone().index_add_(axis, idx, src)
def _segment_sum(src, seg, n):
    out = torch.zeros((n,) + src.shape[1:], dtype=src.dtype)
    return out.index_add_(0, seg, src)
def _pad(x, pw):
    flat = tuple(v for pair in reversed(pw) for v in pair)
    return torch.nn.functional.pad(x, flat)

kernel_name = 'sequential_preLN__sliding_block_cached__moe_arch_mod__decode'

def setup_inputs():

    _w = (lambda a: (lambda t: t.to(torch.bfloat16) if t.is_floating_point() else t)(torch.as_tensor(a)))
    def _A_setup():
        B, Sq, D = 8, 1, 576
        Hq, Hkv, Sk, Dh = 32, 16, 4096, 128
        assert Hq % Hkv == 0, (Hq, Hkv)
        return {
            "x": _w((lambda *s: torch.randn(*s, dtype=torch.bfloat16) * 0.05)(B, Sq, D)),
            "k_cache": _w((lambda *s: torch.randn(*s, dtype=torch.bfloat16) * 3.2)(B, Hkv, Sk, Dh)),
            "v_cache": _w((lambda *s: torch.randn(*s, dtype=torch.bfloat16) * 0.4)(B, Hkv, Sk, Dh)),
            "wq": _w((lambda *s: torch.randn(*s, dtype=torch.bfloat16) * 3.2)(D, Hq * Dh) * (D ** -0.5)),
            "wo": _w((lambda *s: torch.randn(*s, dtype=torch.bfloat16) * 0.4)(Hq * Dh, D) * ((Hq * Dh) ** -0.5)),
        }
    _A_in = _A_setup()

    def _B_setup():
        B, S, D, F, C = 8, 1, 576, 4608, 1
        return {
            "x": _w((lambda *s: torch.randn(*s, dtype=torch.bfloat16) * 0.05)(B, S, D)),
            "w_r": _w((lambda *s: torch.randn(*s, dtype=torch.bfloat16) * 0.4)(D)),
            "w_gate": _w((lambda *s: torch.randn(*s, dtype=torch.bfloat16) * 0.05)(D, F)),
            "w_up": _w((lambda *s: torch.randn(*s, dtype=torch.bfloat16) * 0.05)(D, F)),
            "w_down": _w((lambda *s: torch.randn(*s, dtype=torch.bfloat16) * 0.05)(F, D)),
        }
    _B_in = _B_setup()

    return {
        "A_x": _A_in["x"],
        "A_k_cache": _A_in["k_cache"],
        "A_v_cache": _A_in["v_cache"],
        "A_wq": _A_in["wq"],
        "A_wo": _A_in["wo"],
        "B_x": _B_in["x"],
        "B_w_r": _B_in["w_r"],
        "B_w_gate": _B_in["w_gate"],
        "B_w_up": _B_in["w_up"],
        "B_w_down": _B_in["w_down"],
    }

def reference(A_x, A_k_cache, A_v_cache, A_wq, A_wo, B_x, B_w_r, B_w_gate, B_w_up, B_w_down):
    def _A_ref(x, k_cache, v_cache, wq, wo):
        B, Sq, D = x.shape
        Hq, Dh = 32, 128
        Hkv, Sk = k_cache.shape[1], k_cache.shape[2]
        W = min(4096, max(256, Sk // 4))
        rep = Hq // Hkv
        q = (lambda x, *d: x.permute(*d))((x @ wq).reshape(B, Sq, Hq, Dh), 0, 2, 1, 3)
        k = (lambda x, n, axis: torch.repeat_interleave(x, n, dim=axis))(k_cache[:, :, Sk - W:, :], rep, axis=1)
        v = (lambda x, n, axis: torch.repeat_interleave(x, n, dim=axis))(v_cache[:, :, Sk - W:, :], rep, axis=1)
        scores = torch.einsum("bhqd,bhkd->bhqk", q, k) * (Dh ** -0.5)
        p = _softmax(scores, axis=-1)
        o = torch.einsum("bhqk,bhkd->bhqd", p, v)
        return (lambda x, *d: x.permute(*d))(o, 0, 2, 1, 3).reshape(B, Sq, Hq * Dh) @ wo

    def _B_ref(x, w_r, w_gate, w_up, w_down):
        B, S, D = x.shape
        C = 1
        r = x @ w_r
        idx = torch.argsort(-r, axis=-1)[:, :C]
        idx_e = (lambda x, n, axis: torch.repeat_interleave(x, n, dim=axis))(idx.reshape(B, C, 1), D, axis=2)
        x_sel = (lambda x, i, axis: torch.take_along_dim(x, i, dim=axis))(x, idx_e, axis=1)
        g = _silu(x_sel @ w_gate)
        u = x_sel @ w_up
        y = (g * u) @ w_down
        r_sel = _sigmoid((lambda x, i, axis: torch.take_along_dim(x, i, dim=axis))(r, idx, axis=1))
        y = y * r_sel.reshape(B, C, 1)
        b_off = (torch.arange(B) * S).reshape(B, 1)
        flat_idx = (idx + b_off).reshape(B * C)
        zero = (x * 0.0).reshape(B * S, D)
        upd = _scatter_add(zero, flat_idx, y.reshape(B * C, D), axis=0)
        return x + upd.reshape(B, S, D)

    x = A_x
    h = x + _A_ref(_layernorm(x, axis=-1), A_k_cache, A_v_cache, A_wq, A_wo)
    h2 = h + _B_ref(_layernorm(h, axis=-1), B_w_r, B_w_gate, B_w_up, B_w_down)
    return h2
```

```asm
; @launch grid=(256,1,1) block=(512,1,1) lds=140800
.amdgcn_target "amdgcn-amd-amdhsa--gfx950"
.text
.globl sequential_preLN__sliding_block_cached__moe_arch_mod__decode_kernel
.p2align 8
.type sequential_preLN__sliding_block_cached__moe_arch_mod__decode_kernel,@function
sequential_preLN__sliding_block_cached__moe_arch_mod__decode_kernel:
L_start:
    s_load_dwordx16 s[4:19], s[0:1], 0
    s_load_dwordx8 s[20:27], s[0:1], 64
    s_load_dwordx2 s[28:29], s[0:1], 96
    s_cmp_ge_u32 s2, 256
    s_cbranch_scc1 L_end
    s_getpc_b64 s[62:63]
L_pc:
    s_lshr_b32 s51, s2, 3
    s_and_b32 s57, s51, 15
    s_lshl_b32 s57, s57, 11
    v_lshl_add_u32 v11, v0, 2, s57
    v_min_u32 v11, L_end-L_pc, v11
    global_load_dword v25, v11, s[62:63]
    v_and_b32 v1, 63, v0
    v_lshrrev_b32 v2, 6, v0
    v_mov_b32 v4, 0
    v_mov_b32 v5, 0
    v_readfirstlane_b32 s48, v2
    ds_write2_b64 v4, v[4:5], v[4:5] offset0:0 offset1:1
    ds_write2_b64 v4, v[4:5], v[4:5] offset0:2 offset1:3
    s_and_b32 s50, s2, 7
    s_lshr_b32 s52, s51, 4
    s_lshl_b32 s57, s50, 1
    s_add_u32 s52, s52, s57
    s_and_b32 s53, s51, 15
    s_lshr_b32 s54, s53, 1
    s_and_b32 s55, s53, 1
    s_and_b32 s49, s48, 3
    s_lshl_b32 s56, s54, 4
    s_add_u32 s56, s56, s52
    s_lshl_b32 s56, s56, 20
    s_lshl_b32 s57, s55, 17
    s_add_u32 s56, s56, s57
    s_lshl_b32 s57, s49, 15
    s_add_u32 s56, s56, s57
    s_add_u32 s56, s56, 786432
    v_and_b32 v2, 15, v1
    v_lshrrev_b32 v3, 4, v1
    v_lshlrev_b32 v6, 8, v2
    v_lshl_add_u32 v6, v3, 4, v6
    v_lshrrev_b32 v9, 5, v1
    s_lshl_b32 s57, s49, 1
    v_add_u32 v9, s57, v9
    v_mul_u32_u24 v9, 1152, v9
    v_and_b32 v8, 31, v1
    v_lshl_add_u32 v9, v8, 2, v9
    v_mul_u32_u24 v8, 12, v8
    v_add_u32 v8, v8, v9
    s_mov_b32 s34, 134217728
    s_mov_b32 s35, 0x20000
    s_mov_b32 s42, 9216
    s_mov_b32 s43, 0x20000
    s_sub_u32 s3, s51, 18
    s_cmp_ge_u32 s3, 9
    s_cselect_b32 s3, 1, 0
    s_cmp_ge_u32 s48, 4
    s_waitcnt lgkmcnt(0)
    s_cbranch_scc0 L_vwave
    s_setprio 2
    s_mov_b32 s32, s6
    s_mov_b32 s33, s7
    s_add_u32 s57, s56, 0
    buffer_load_dwordx4 v[128:131], v6, s[32:35], s57 offen offset:0 nt
    buffer_load_dwordx4 v[132:135], v6, s[32:35], s57 offen offset:64 nt
    buffer_load_dwordx4 v[136:139], v6, s[32:35], s57 offen offset:128 nt
    buffer_load_dwordx4 v[140:143], v6, s[32:35], s57 offen offset:192 nt
    s_load_dwordx2 s[30:31], s[28:29], 0
    s_mov_b32 s36, s28
    s_mov_b32 s37, s29
    s_mov_b32 s38, 4194304
    s_mov_b32 s39, 0x20000
    v_and_b32 v7, 31, v1
    v_lshlrev_b32 v17, 2, v7
    v_lshlrev_b32 v7, 4, v7
    v_lshrrev_b32 v8, 5, v1
    v_lshl_add_u32 v7, v8, 11, v7
    v_add_u32 v13, 4096, v7
    s_lshl_b32 s57, s52, 3
    s_add_u32 s57, s57, s54
    s_lshl_b32 s57, s57, 13
    s_lshl_b32 s58, s49, 9
    s_add_u32 s57, s57, s58
    s_add_u32 s59, s57, 2097152
    s_lshl_b32 s57, s49, 7
    v_add_u32 v17, s57, v17
    s_add_u32 s57, s56, 4096
    buffer_load_dwordx4 v[144:147], v6, s[32:35], s57 offen offset:0 nt
    buffer_load_dwordx4 v[148:151], v6, s[32:35], s57 offen offset:64 nt
    buffer_load_dwordx4 v[152:155], v6, s[32:35], s57 offen offset:128 nt
    buffer_load_dwordx4 v[156:159], v6, s[32:35], s57 offen offset:192 nt
    s_barrier
    s_add_u32 s57, s56, 8192
    buffer_load_dwordx4 v[160:163], v6, s[32:35], s57 offen offset:0 nt
    buffer_load_dwordx4 v[164:167], v6, s[32:35], s57 offen offset:64 nt
    buffer_load_dwordx4 v[168:171], v6, s[32:35], s57 offen offset:128 nt
    buffer_load_dwordx4 v[172:175], v6, s[32:35], s57 offen offset:192 nt
    s_add_u32 s57, s56, 12288
    buffer_load_dwordx4 v[176:179], v6, s[32:35], s57 offen offset:0 nt
    buffer_load_dwordx4 v[180:183], v6, s[32:35], s57 offen offset:64 nt
    buffer_load_dwordx4 v[184:187], v6, s[32:35], s57 offen offset:128 nt
    buffer_load_dwordx4 v[188:191], v6, s[32:35], s57 offen offset:192 nt
    s_add_u32 s57, s56, 16384
    buffer_load_dwordx4 v[192:195], v6, s[32:35], s57 offen offset:0 nt
    buffer_load_dwordx4 v[196:199], v6, s[32:35], s57 offen offset:64 nt
    buffer_load_dwordx4 v[200:203], v6, s[32:35], s57 offen offset:128 nt
    buffer_load_dwordx4 v[204:207], v6, s[32:35], s57 offen offset:192 nt
    s_add_u32 s57, s56, 20480
    buffer_load_dwordx4 v[208:211], v6, s[32:35], s57 offen offset:0 nt
    buffer_load_dwordx4 v[212:215], v6, s[32:35], s57 offen offset:64 nt
    buffer_load_dwordx4 v[216:219], v6, s[32:35], s57 offen offset:128 nt
    buffer_load_dwordx4 v[220:223], v6, s[32:35], s57 offen offset:192 nt
    buffer_load_dwordx4 v[112:115], v7, s[36:39], s59 offen sc1
    buffer_load_dwordx4 v[116:119], v13, s[36:39], s59 offen sc1
    s_add_u32 s57, s56, 24576
    buffer_load_dwordx4 v[224:227], v6, s[32:35], s57 offen offset:0 nt
    buffer_load_dwordx4 v[228:231], v6, s[32:35], s57 offen offset:64 nt
    buffer_load_dwordx4 v[232:235], v6, s[32:35], s57 offen offset:128 nt
    buffer_load_dwordx4 v[236:239], v6, s[32:35], s57 offen offset:192 nt
    s_add_u32 s57, s56, 28672
    buffer_load_dwordx4 v[240:243], v6, s[32:35], s57 offen offset:0 nt
    buffer_load_dwordx4 v[244:247], v6, s[32:35], s57 offen offset:64 nt
    buffer_load_dwordx4 v[248:251], v6, s[32:35], s57 offen offset:128 nt
    buffer_load_dwordx4 v[252:255], v6, s[32:35], s57 offen offset:192 nt
    s_branch L_kwave
L_vwave:
    s_setprio 3
    s_mov_b32 s40, s4
    s_mov_b32 s41, s5
    buffer_load_dwordx4 v[16:19], v8, s[40:43], 0 offen
    buffer_load_dwordx4 v[20:23], v8, s[40:43], 0 offen offset:512
    buffer_load_dword v24, v9, s[40:43], 0 offen offset:1024
    s_mov_b32 s44, s10
    s_mov_b32 s45, s11
    s_mov_b32 s46, 4718592
    s_mov_b32 s47, 0x20000
    v_lshrrev_b32 v10, 3, v1
    v_lshlrev_b32 v10, 13, v10
    v_bfe_u32 v11, v1, 4, 2
    v_lshlrev_b32 v11, 1, v11
    v_and_b32 v12, 7, v1
    v_xor_b32 v11, v11, v12
    v_lshl_add_u32 v10, v11, 4, v10
    s_lshr_b32 s61, s53, 2
    s_and_b32 s62, s53, 3
    s_mul_i32 s58, s61, 1179648
    s_lshl_b32 s57, s52, 9
    s_add_u32 s58, s58, s57
    s_lshl_b32 s57, s62, 7
    s_add_u32 s58, s58, s57
    s_mov_b32 s60, 0
    s_add_u32 s60, s60, s49
    s_lshl_b32 s57, s60, 10
    s_add_u32 s57, s57, 25600
    s_mov_b32 m0, s57
    s_lshl_b32 s57, s60, 16
    s_add_u32 s57, s57, s58
    buffer_load_dwordx4 v10, s[44:47], s57 offen nt lds
    s_add_u32 s60, s60, 4
    s_lshl_b32 s57, s60, 10
    s_add_u32 s57, s57, 25600
    s_mov_b32 m0, s57
    s_lshl_b32 s57, s60, 16
    s_add_u32 s57, s57, s58
    buffer_load_dwordx4 v10, s[44:47], s57 offen nt lds
    s_add_u32 s60, s60, 4
    s_lshl_b32 s57, s60, 10
    s_add_u32 s57, s57, 25600
    s_mov_b32 m0, s57
    s_lshl_b32 s57, s60, 16
    s_add_u32 s57, s57, s58
    buffer_load_dwordx4 v10, s[44:47], s57 offen nt lds
    s_add_u32 s60, s60, 4
    s_lshl_b32 s57, s60, 10
    s_add_u32 s57, s57, 25600
    s_mov_b32 m0, s57
    s_lshl_b32 s57, s60, 16
    s_add_u32 s57, s57, s58
    buffer_load_dwordx4 v10, s[44:47], s57 offen nt lds
    s_add_u32 s60, s60, 4
    s_cmp_ge_u32 s49, 2
    s_cbranch_scc1 L_wq4
    s_lshl_b32 s57, s60, 10
    s_add_u32 s57, s57, 25600
    s_mov_b32 m0, s57
    s_lshl_b32 s57, s60, 16
    s_add_u32 s57, s57, s58
    buffer_load_dwordx4 v10, s[44:47], s57 offen nt lds
    s_add_u32 s60, s60, 4
L_wq4:
    s_load_dwordx2 s[30:31], s[28:29], 0
    s_mov_b32 s36, s28
    s_mov_b32 s37, s29
    s_mov_b32 s38, 4194304
    s_mov_b32 s39, 0x20000
    v_lshlrev_b32 v11, 4, v0
    v_mov_b32 v10, 0x7ffffff0
    v_cmp_gt_u32 vcc, 202, v0
    s_nop 1
    v_cndmask_b32 v11, v10, v11, vcc
    v_mov_b32 v12, -1
    v_mov_b32 v13, -1
    v_mov_b32 v14, -1
    v_mov_b32 v15, -1
    s_mul_i32 s60, s2, 3232
    s_add_u32 s60, s60, 524288
    buffer_store_dwordx4 v[12:15], v11, s[36:39], s60 offen sc1
    s_barrier
    s_mov_b32 s32, s8
    s_mov_b32 s33, s9
    s_mov_b32 s98, 0x05040100
    s_mov_b32 s99, 0x07060302
    s_mov_b32 s100, 0xffff0000
    v_lshrrev_b32 v10, 5, v1
    s_lshl_b32 s57, s49, 1
    v_add_u32 v10, s57, v10
    v_lshlrev_b32 v10, 5, v10
    v_add_u32 v8, v8, v10
    v_add_u32 v9, v9, v10
    v_bfe_u32 v6, v1, 2, 2
    v_lshl_add_u32 v6, v3, 2, v6
    v_bfe_u32 v7, v6, 1, 2
    v_xor_b32 v7, s49, v7
    v_lshlrev_b32 v7, 5, v7
    v_lshl_add_u32 v6, v6, 7, v7
    v_and_b32 v7, 3, v1
    v_lshl_add_u32 v6, v7, 3, v6
    v_and_b32 v7, 7, v1
    v_mul_u32_u24 v7, 1184, v7
    v_lshl_add_u32 v7, v3, 3, v7
    s_mul_i32 s57, s61, 288
    v_add_u32 v7, s57, v7
    s_waitcnt vmcnt(5)
    s_mov_b32 s57, 0x3f803f80
    v_dot2_f32_bf16 v26, v16, s57, 0
    v_dot2_f32_bf16 v28, v16, v16, 0
    v_dot2_f32_bf16 v26, v17, s57, v26
    v_dot2_f32_bf16 v28, v17, v17, v28
    v_dot2_f32_bf16 v26, v18, s57, v26
    v_dot2_f32_bf16 v28, v18, v18, v28
    v_dot2_f32_bf16 v26, v19, s57, v26
    v_dot2_f32_bf16 v28, v19, v19, v28
    v_dot2_f32_bf16 v26, v20, s57, v26
    v_dot2_f32_bf16 v28, v20, v20, v28
    v_dot2_f32_bf16 v26, v21, s57, v26
    v_dot2_f32_bf16 v28, v21, v21, v28
    v_dot2_f32_bf16 v26, v22, s57, v26
    v_dot2_f32_bf16 v28, v22, v22, v28
    v_dot2_f32_bf16 v26, v23, s57, v26
    v_dot2_f32_bf16 v28, v23, v23, v28
    v_dot2_f32_bf16 v26, v24, s57, v26
    v_dot2_f32_bf16 v28, v24, v24, v28
    v_lshlrev_b32 v34, 16, v16
    v_and_b32 v35, s100, v16
    v_lshlrev_b32 v36, 16, v17
    v_add_f32_dpp v26, v26, v26 row_ror:8 row_mask:0xf bank_mask:0xf
    v_add_f32_dpp v28, v28, v28 row_ror:8 row_mask:0xf bank_mask:0xf
    v_and_b32 v37, s100, v17
    v_lshlrev_b32 v38, 16, v18
    v_add_f32_dpp v26, v26, v26 row_ror:4 row_mask:0xf bank_mask:0xf
    v_add_f32_dpp v28, v28, v28 row_ror:4 row_mask:0xf bank_mask:0xf
    v_and_b32 v39, s100, v18
    v_lshlrev_b32 v40, 16, v19
    v_add_f32_dpp v26, v26, v26 row_ror:2 row_mask:0xf bank_mask:0xf
    v_add_f32_dpp v28, v28, v28 row_ror:2 row_mask:0xf bank_mask:0xf
    v_and_b32 v41, s100, v19
    v_lshlrev_b32 v42, 16, v20
    v_add_f32_dpp v26, v26, v26 row_ror:1 row_mask:0xf bank_mask:0xf
    v_add_f32_dpp v28, v28, v28 row_ror:1 row_mask:0xf bank_mask:0xf
    v_and_b32 v43, s100, v20
    v_lshlrev_b32 v44, 16, v21
    v_mov_b32 v27, v26
    v_mov_b32 v29, v28
    v_and_b32 v45, s100, v21
    v_permlane16_swap_b32 v26, v27
    v_permlane16_swap_b32 v28, v29
    v_add_f32 v26, v26, v27
    v_add_f32 v28, v28, v29
    v_mul_f32 v26, 0x3ae38e39, v26
    v_mul_f32 v28, 0x3ae38e39, v28
    v_lshlrev_b32 v46, 16, v22
    v_fma_f32 v28, -v26, v26, v28
    v_and_b32 v47, s100, v22
    v_max_f32 v28, 0, v28
    v_lshlrev_b32 v48, 16, v23
    v_cvt_pk_bf16_f32 v30, v26, v28
    v_and_b32 v49, s100, v23
    v_lshlrev_b32 v50, 16, v24
    v_and_b32 v51, s100, v24
    v_lshlrev_b32 v26, 16, v30
    v_and_b32 v28, s100, v30
    v_add_f32 v28, 0x3727c5ac, v28
    v_cvt_pk_bf16_f32 v28, v28, v28
    v_pk_add_f32 v[34:35], v[34:35], v[26:27] op_sel_hi:[1,0] neg_lo:[0,1] neg_hi:[0,1]
    v_lshlrev_b32 v28, 16, v28
    v_pk_add_f32 v[36:37], v[36:37], v[26:27] op_sel_hi:[1,0] neg_lo:[0,1] neg_hi:[0,1]
    v_sqrt_f32 v28, v28
    v_pk_add_f32 v[38:39], v[38:39], v[26:27] op_sel_hi:[1,0] neg_lo:[0,1] neg_hi:[0,1]
    v_pk_add_f32 v[40:41], v[40:41], v[26:27] op_sel_hi:[1,0] neg_lo:[0,1] neg_hi:[0,1]
    v_cvt_pk_bf16_f32 v28, v28, v28
    v_pk_add_f32 v[42:43], v[42:43], v[26:27] op_sel_hi:[1,0] neg_lo:[0,1] neg_hi:[0,1]
    v_lshlrev_b32 v28, 16, v28
    v_pk_add_f32 v[44:45], v[44:45], v[26:27] op_sel_hi:[1,0] neg_lo:[0,1] neg_hi:[0,1]
    v_rcp_f32 v28, v28
    v_pk_add_f32 v[46:47], v[46:47], v[26:27] op_sel_hi:[1,0] neg_lo:[0,1] neg_hi:[0,1]
    v_pk_add_f32 v[48:49], v[48:49], v[26:27] op_sel_hi:[1,0] neg_lo:[0,1] neg_hi:[0,1]
    v_pk_add_f32 v[50:51], v[50:51], v[26:27] op_sel_hi:[1,0] neg_lo:[0,1] neg_hi:[0,1]
    v_cvt_pk_bf16_f32 v52, v34, v35
    v_cvt_pk_bf16_f32 v53, v36, v37
    v_cvt_pk_bf16_f32 v54, v38, v39
    v_cvt_pk_bf16_f32 v55, v40, v41
    v_cvt_pk_bf16_f32 v56, v42, v43
    v_cvt_pk_bf16_f32 v57, v44, v45
    v_cvt_pk_bf16_f32 v58, v46, v47
    v_cvt_pk_bf16_f32 v59, v48, v49
    v_cvt_pk_bf16_f32 v60, v50, v51
    v_lshlrev_b32 v34, 16, v52
    v_and_b32 v35, s100, v52
    v_lshlrev_b32 v36, 16, v53
    v_and_b32 v37, s100, v53
    v_lshlrev_b32 v38, 16, v54
    v_and_b32 v39, s100, v54
    v_lshlrev_b32 v40, 16, v55
    v_and_b32 v41, s100, v55
    v_lshlrev_b32 v42, 16, v56
    v_and_b32 v43, s100, v56
    v_lshlrev_b32 v44, 16, v57
    v_and_b32 v45, s100, v57
    v_lshlrev_b32 v46, 16, v58
    v_and_b32 v47, s100, v58
    v_lshlrev_b32 v48, 16, v59
    v_and_b32 v49, s100, v59
    v_lshlrev_b32 v50, 16, v60
    v_and_b32 v51, s100, v60
    v_pk_mul_f32 v[34:35], v[34:35], v[28:29] op_sel_hi:[1,0]
    v_pk_mul_f32 v[36:37], v[36:37], v[28:29] op_sel_hi:[1,0]
    v_pk_mul_f32 v[38:39], v[38:39], v[28:29] op_sel_hi:[1,0]
    v_pk_mul_f32 v[40:41], v[40:41], v[28:29] op_sel_hi:[1,0]
    v_pk_mul_f32 v[42:43], v[42:43], v[28:29] op_sel_hi:[1,0]
    v_pk_mul_f32 v[44:45], v[44:45], v[28:29] op_sel_hi:[1,0]
    v_pk_mul_f32 v[46:47], v[46:47], v[28:29] op_sel_hi:[1,0]
    v_pk_mul_f32 v[48:49], v[48:49], v[28:29] op_sel_hi:[1,0]
    v_pk_mul_f32 v[50:51], v[50:51], v[28:29] op_sel_hi:[1,0]
    v_cvt_pk_bf16_f32 v52, v34, v35
    v_cvt_pk_bf16_f32 v53, v36, v37
    v_cvt_pk_bf16_f32 v54, v38, v39
    v_cvt_pk_bf16_f32 v55, v40, v41
    v_cvt_pk_bf16_f32 v56, v42, v43
    v_cvt_pk_bf16_f32 v57, v44, v45
    v_cvt_pk_bf16_f32 v58, v46, v47
    v_cvt_pk_bf16_f32 v59, v48, v49
    v_cvt_pk_bf16_f32 v60, v50, v51
    ds_write_b128 v8, v[52:55] offset:44032
    ds_write_b128 v8, v[56:59] offset:44544
    ds_write_b32 v9, v60 offset:45056
    v_mov_b32 v4, 0
    v_mov_b32 v5, 1
    s_waitcnt vmcnt(0) lgkmcnt(0)
    s_mov_b32 exec_lo, 0x1
    s_mov_b32 exec_hi, 0x0
    ds_add_u32 v4, v5 offset:0
    s_mov_b64 exec, -1
    s_add_u32 s30, s30, 1
    s_getreg_b32 s57, hwreg(HW_REG_XCC_ID, 0, 4)
    s_mul_i32 s58, s57, s57
    s_lshl_b32 s58, s58, 16
    s_lshl_b32 s57, s57, 8
    s_add_u32 s57, s57, s58
    s_add_u32 s57, s57, 1
    v_mov_b32 v8, s57
    s_lshl_b32 s58, s50, 5
    v_mov_b32 v9, s58
    v_mov_b32 v82, 0
    v_mov_b32 v83, 0
    v_mov_b32 v102, 0
    v_mov_b32 v103, 0
    v_and_b32 v11, 7, v1
    v_lshlrev_b32 v11, 13, v11
    v_lshl_add_u32 v11, v3, 5, v11
    v_and_b32 v10, 8, v1
    v_lshl_add_u32 v11, v10, 1, v11
    s_lshl_b32 s57, s52, 16
    s_lshl_b32 s58, s61, 11
    s_add_u32 s57, s57, s58
    s_lshl_b32 s58, s62, 9
    s_add_u32 s57, s57, s58
    s_lshl_b32 s58, s49, 7
    s_add_u32 s57, s57, s58
    s_add_u32 s59, s57, 2097152
    v_mov_b32 v33, s30
    v_mov_b32 v35, s30
    v_cmp_gt_u32 s[60:61], 8, v2
    s_mov_b32 s97, 0
    s_nop 3
L_spin_1:
    ds_read_b32 v10, v4 offset:0
    s_add_u32 s97, s97, 1
    s_waitcnt lgkmcnt(0)
    v_readfirstlane_b32 s57, v10
    s_cmp_ge_u32 s97, 1048576
    s_nop 2
    s_cbranch_scc1 L_spd_2
    s_cmp_lt_u32 s57, 4
    s_cbranch_scc1 L_spin_1
L_spd_2:
    ds_read_b64_tr_b16 v[64:65], v6 offset:25600
    ds_read_b64 v[84:85], v7 offset:44032
    ds_read_b64_tr_b16 v[66:67], v6 offset:27648
    ds_read_b64 v[86:87], v7 offset:44064
    ds_read_b64_tr_b16 v[68:69], v6 offset:29696
    ds_read_b64 v[88:89], v7 offset:44096
    ds_read_b64_tr_b16 v[70:71], v6 offset:31744
    ds_read_b64 v[90:91], v7 offset:44128
    ds_read_b64_tr_b16 v[72:73], v6 offset:33792
    ds_read_b64 v[92:93], v7 offset:44160
    ds_read_b64_tr_b16 v[74:75], v6 offset:35840
    ds_read_b64 v[94:95], v7 offset:44192
    s_waitcnt lgkmcnt(8)
    ds_read_b64_tr_b16 v[76:77], v6 offset:37888
    ds_read_b64 v[96:97], v7 offset:44224
    ds_read_b64_tr_b16 v[78:79], v6 offset:39936
    ds_read_b64 v[98:99], v7 offset:44256
    ds_read_b64_tr_b16 v[80:81], v6 offset:41984
    ds_read_b64 v[100:101], v7 offset:44288
    s_cmp_lg_u32 s48, 0
    s_cbranch_scc1 L_noatom
    s_mov_b32 exec_lo, 0x1
    s_mov_b32 exec_hi, 0x0
    global_atomic_add v9, v8, s[26:27]
    s_mov_b64 exec, -1
L_noatom:
    s_waitcnt lgkmcnt(14)
    v_mfma_f32_16x16x32_bf16 v[28:31], v[64:67], v[84:87], 0
    s_waitcnt lgkmcnt(10)
    v_mfma_f32_16x16x32_bf16 v[28:31], v[68:71], v[88:91], v[28:31]
    s_waitcnt lgkmcnt(6)
    v_mfma_f32_16x16x32_bf16 v[28:31], v[72:75], v[92:95], v[28:31]
    s_waitcnt lgkmcnt(2)
    v_mfma_f32_16x16x32_bf16 v[28:31], v[76:79], v[96:99], v[28:31]
    s_waitcnt lgkmcnt(0)
    v_mfma_f32_16x16x32_bf16 v[28:31], v[80:83], v[100:103], v[28:31]
    s_nop 7
    v_cndmask_b32 v32, v30, v28, s[60:61]
    v_cndmask_b32 v34, v31, v29, s[60:61]
    buffer_store_dwordx4 v[32:35], v11, s[36:39], s59 offen sc1
    s_setprio 1
    v_and_b32 v7, 3, v2
    v_lshlrev_b32 v7, 2, v7
    v_lshrrev_b32 v8, 2, v2
    v_add_u32 v7, v7, v8
    v_lshlrev_b32 v6, 10, v3
    v_lshl_add_u32 v6, v7, 4, v6
    s_add_u32 s57, s56, 0
    buffer_load_dwordx4 v[128:131], v6, s[32:35], s57 offen offset:0 nt
    buffer_load_dwordx4 v[132:135], v6, s[32:35], s57 offen offset:256 nt
    buffer_load_dwordx4 v[136:139], v6, s[32:35], s57 offen offset:512 nt
    buffer_load_dwordx4 v[140:143], v6, s[32:35], s57 offen offset:768 nt
    s_add_u32 s57, s56, 4096
    buffer_load_dwordx4 v[144:147], v6, s[32:35], s57 offen offset:0 nt
    buffer_load_dwordx4 v[148:151], v6, s[32:35], s57 offen offset:256 nt
    buffer_load_dwordx4 v[152:155], v6, s[32:35], s57 offen offset:512 nt
    buffer_load_dwordx4 v[156:159], v6, s[32:35], s57 offen offset:768 nt
    s_add_u32 s57, s56, 8192
    buffer_load_dwordx4 v[160:163], v6, s[32:35], s57 offen offset:0 nt
    buffer_load_dwordx4 v[164:167], v6, s[32:35], s57 offen offset:256 nt
    buffer_load_dwordx4 v[168:171], v6, s[32:35], s57 offen offset:512 nt
    buffer_load_dwordx4 v[172:175], v6, s[32:35], s57 offen offset:768 nt
    s_add_u32 s57, s56, 12288
    buffer_load_dwordx4 v[176:179], v6, s[32:35], s57 offen offset:0 nt
    buffer_load_dwordx4 v[180:183], v6, s[32:35], s57 offen offset:256 nt
    buffer_load_dwordx4 v[184:187], v6, s[32:35], s57 offen offset:512 nt
    buffer_load_dwordx4 v[188:191], v6, s[32:35], s57 offen offset:768 nt
    s_add_u32 s57, s56, 16384
    buffer_load_dwordx4 v[192:195], v6, s[32:35], s57 offen offset:0 nt
    buffer_load_dwordx4 v[196:199], v6, s[32:35], s57 offen offset:256 nt
    buffer_load_dwordx4 v[200:203], v6, s[32:35], s57 offen offset:512 nt
    buffer_load_dwordx4 v[204:207], v6, s[32:35], s57 offen offset:768 nt
    s_add_u32 s57, s56, 20480
    buffer_load_dwordx4 v[208:211], v6, s[32:35], s57 offen offset:0 nt
    buffer_load_dwordx4 v[212:215], v6, s[32:35], s57 offen offset:256 nt
    buffer_load_dwordx4 v[216:219], v6, s[32:35], s57 offen offset:512 nt
    buffer_load_dwordx4 v[220:223], v6, s[32:35], s57 offen offset:768 nt
    s_add_u32 s57, s56, 24576
    buffer_load_dwordx4 v[224:227], v6, s[32:35], s57 offen offset:0 nt
    buffer_load_dwordx4 v[228:231], v6, s[32:35], s57 offen offset:256 nt
    buffer_load_dwordx4 v[232:235], v6, s[32:35], s57 offen offset:512 nt
    buffer_load_dwordx4 v[236:239], v6, s[32:35], s57 offen offset:768 nt
    s_add_u32 s57, s56, 28672
    buffer_load_dwordx4 v[240:243], v6, s[32:35], s57 offen offset:0 nt
    buffer_load_dwordx4 v[244:247], v6, s[32:35], s57 offen offset:256 nt
    buffer_load_dwordx4 v[248:251], v6, s[32:35], s57 offen offset:512 nt
    buffer_load_dwordx4 v[252:255], v6, s[32:35], s57 offen offset:768 nt
    s_setprio 3
    s_mov_b32 exec_lo, 0x1
    s_mov_b32 exec_hi, 0x0
    ds_add_u32 v4, v5 offset:20
    s_mov_b64 exec, -1
    s_lshl_b32 s57, s49, 12
    s_add_u32 s57, s57, 6400
    v_and_b32 v7, 1, v1
    v_lshlrev_b32 v8, 8, v3
    v_add_u32 v8, s57, v8
    v_lshl_add_u32 v9, v7, 4, v8
    v_add_u32 v8, 32, v8
    v_lshrrev_b32 v27, 1, v2
    v_cmp_eq_u32 vcc, 0, v27
    s_nop 1
    v_cndmask_b32 v16, v8, v9, vcc
    v_cmp_eq_u32 vcc, 1, v27
    s_nop 1
    v_cndmask_b32 v17, v8, v9, vcc
    v_cmp_eq_u32 vcc, 2, v27
    s_nop 1
    v_cndmask_b32 v18, v8, v9, vcc
    v_cmp_eq_u32 vcc, 3, v27
    s_nop 1
    v_cndmask_b32 v19, v8, v9, vcc
    v_cmp_eq_u32 vcc, 4, v27
    s_nop 1
    v_cndmask_b32 v20, v8, v9, vcc
    v_cmp_eq_u32 vcc, 5, v27
    s_nop 1
    v_cndmask_b32 v21, v8, v9, vcc
    v_cmp_eq_u32 vcc, 6, v27
    s_nop 1
    v_cndmask_b32 v22, v8, v9, vcc
    v_cmp_eq_u32 vcc, 7, v27
    s_nop 1
    v_cndmask_b32 v23, v8, v9, vcc
    v_lshlrev_b32 v11, 3, v7
    s_mov_b32 s97, 0
    s_nop 0
L_spin_3:
    ds_read_b32 v10, v4 offset:16
    s_add_u32 s97, s97, 1
    s_waitcnt lgkmcnt(0)
    v_readfirstlane_b32 s57, v10
    s_cmp_ge_u32 s97, 1048576
    s_nop 2
    s_cbranch_scc1 L_spd_4
    s_cmp_lt_u32 s57, 4
    s_cbranch_scc1 L_spin_3
L_spd_4:
    ds_read_b64 v[32:33], v11 offset:64
    ds_read_b64 v[34:35], v11 offset:80
    ds_read_b64 v[36:37], v11 offset:96
    ds_read_b64 v[38:39], v11 offset:112
    s_lshl_b32 s57, s49, 4
    v_add_u32 v13, s57, v11
    ds_read_b32 v40, v13 offset:64
    ds_read_b128 v[96:99], v16
    ds_read_b128 v[100:103], v17
    ds_read_b128 v[104:107], v18
    ds_read_b128 v[108:111], v19
    ds_read_b128 v[112:115], v20
    ds_read_b128 v[116:119], v21
    ds_read_b128 v[120:123], v22
    ds_read_b128 v[124:127], v23
    s_waitcnt lgkmcnt(8)
    v_max3_f32 v41, v32, v34, v36
    v_max_f32 v41, v41, v38
    s_mov_b32 s57, 0x3fb8aa3b
    v_sub_f32 v32, v32, v41
    v_mul_f32 v32, s57, v32
    v_exp_f32 v32, v32
    v_sub_f32 v34, v34, v41
    v_mul_f32 v34, s57, v34
    v_exp_f32 v34, v34
    v_sub_f32 v36, v36, v41
    v_mul_f32 v36, s57, v36
    v_exp_f32 v36, v36
    v_sub_f32 v38, v38, v41
    v_mul_f32 v38, s57, v38
    v_exp_f32 v38, v38
    v_sub_f32 v40, v40, v41
    v_mul_f32 v40, s57, v40
    v_exp_f32 v40, v40
    v_mul_f32 v42, v32, v33
    v_fmac_f32 v42, v34, v35
    v_fmac_f32 v42, v36, v37
    v_fmac_f32 v42, v38, v39
    v_rcp_f32 v43, v42
    s_nop 0
    v_mul_f32 v26, v40, v43
    v_min_u32 v41, -2, v41
    v_min_u32 v42, -2, v42
    s_nop 0
    v_mov_b32_dpp v8, v41 quad_perm:[0,0,2,2] row_mask:0xf bank_mask:0xf
    v_mov_b32_dpp v9, v42 quad_perm:[0,0,2,2] row_mask:0xf bank_mask:0xf
    v_mov_b32_dpp v10, v41 quad_perm:[1,1,3,3] row_mask:0xf bank_mask:0xf
    v_mov_b32_dpp v11, v42 quad_perm:[1,1,3,3] row_mask:0xf bank_mask:0xf
    v_lshlrev_b32 v12, 12, v7
    v_lshl_add_u32 v12, v3, 6, v12
    v_lshl_add_u32 v12, v27, 3, v12
    s_lshl_b32 s58, s50, 14
    s_and_b32 s57, s52, 1
    s_lshl_b32 s57, s57, 13
    s_add_u32 s58, s58, s57
    s_lshl_b32 s57, s55, 3
    s_add_u32 s57, s57, s54
    s_lshl_b32 s59, s57, 8
    s_add_u32 s58, s58, s59
    s_add_u32 s58, s58, 524288
    s_lshl_b32 s59, s57, 7
    s_lshl_b32 s57, s52, 11
    s_add_u32 s59, s59, s57
    s_add_u32 s59, s59, 655360
    v_lshlrev_b32 v13, 4, v1
    v_mov_b32 v14, 0x7ffffff0
    v_cmp_gt_u32 vcc, 8, v1
    s_nop 1
    v_cndmask_b32 v13, v14, v13, vcc
    v_lshlrev_b32 v14, 4, v1
    s_lshl_b32 s57, s49, 10
    v_add_u32 v15, s57, v14
    s_mov_b32 s97, 0
    s_nop 0
L_spin_5:
    ds_read_b32 v6, v4 offset:8
    s_add_u32 s97, s97, 1
    s_waitcnt lgkmcnt(0)
    v_readfirstlane_b32 s57, v6
    s_cmp_ge_u32 s97, 1048576
    s_nop 2
    s_cbranch_scc1 L_spd_6
    s_cmp_lt_u32 s57, 1
    s_cbranch_scc1 L_spin_5
L_spd_6:
    s_lshr_b32 s96, s57, 1
    s_waitcnt vmcnt(30)
    v_perm_b32 v64, v132, v128, s98
    v_perm_b32 v68, v132, v128, s99
    v_perm_b32 v72, v133, v129, s98
    v_perm_b32 v76, v133, v129, s99
    v_perm_b32 v80, v134, v130, s98
    v_perm_b32 v84, v134, v130, s99
    v_perm_b32 v88, v135, v131, s98
    v_perm_b32 v92, v135, v131, s99
    s_waitcnt vmcnt(28)
    v_perm_b32 v65, v140, v136, s98
    v_perm_b32 v69, v140, v136, s99
    v_perm_b32 v73, v141, v137, s98
    v_perm_b32 v77, v141, v137, s99
    v_perm_b32 v81, v142, v138, s98
    v_perm_b32 v85, v142, v138, s99
    v_perm_b32 v89, v143, v139, s98
    v_perm_b32 v93, v143, v139, s99
    s_waitcnt vmcnt(26)
    v_perm_b32 v66, v148, v144, s98
    v_perm_b32 v70, v148, v144, s99
    v_perm_b32 v74, v149, v145, s98
    v_perm_b32 v78, v149, v145, s99
    v_perm_b32 v82, v150, v146, s98
    v_perm_b32 v86, v150, v146, s99
    v_perm_b32 v90, v151, v147, s98
    v_perm_b32 v94, v151, v147, s99
    s_waitcnt vmcnt(24)
    v_perm_b32 v67, v156, v152, s98
    v_perm_b32 v71, v156, v152, s99
    v_perm_b32 v75, v157, v153, s98
    v_perm_b32 v79, v157, v153, s99
    v_perm_b32 v83, v158, v154, s98
    v_perm_b32 v87, v158, v154, s99
    v_perm_b32 v91, v159, v155, s98
    v_perm_b32 v95, v159, v155, s99
    s_waitcnt lgkmcnt(0)
    ds_read_b128 v[32:35], v16 offset:1024
    ds_read_b128 v[36:39], v17 offset:1024
    ds_read_b128 v[40:43], v18 offset:1024
    ds_read_b128 v[44:47], v19 offset:1024
    ds_read_b128 v[48:51], v20 offset:1024
    ds_read_b128 v[52:55], v21 offset:1024
    ds_read_b128 v[56:59], v22 offset:1024
    ds_read_b128 v[60:63], v23 offset:1024
    v_mfma_f32_16x16x32_bf16 v[28:31], v[64:67], v[96:99], 0
    v_mfma_f32_16x16x32_bf16 v[28:31], v[68:71], v[100:103], v[28:31]
    v_mfma_f32_16x16x32_bf16 v[28:31], v[72:75], v[104:107], v[28:31]
    v_mfma_f32_16x16x32_bf16 v[28:31], v[76:79], v[108:111], v[28:31]
    v_mfma_f32_16x16x32_bf16 v[28:31], v[80:83], v[112:115], v[28:31]
    v_mfma_f32_16x16x32_bf16 v[28:31], v[84:87], v[116:119], v[28:31]
    v_mfma_f32_16x16x32_bf16 v[28:31], v[88:91], v[120:123], v[28:31]
    v_mfma_f32_16x16x32_bf16 v[28:31], v[92:95], v[124:127], v[28:31]
    s_waitcnt vmcnt(22)
    v_perm_b32 v64, v164, v160, s98
    v_perm_b32 v68, v164, v160, s99
    v_perm_b32 v72, v165, v161, s98
    v_perm_b32 v76, v165, v161, s99
    v_perm_b32 v80, v166, v162, s98
    v_perm_b32 v84, v166, v162, s99
    v_perm_b32 v88, v167, v163, s98
    v_perm_b32 v92, v167, v163, s99
    s_waitcnt vmcnt(20)
    v_perm_b32 v65, v172, v168, s98
    v_perm_b32 v69, v172, v168, s99
    v_perm_b32 v73, v173, v169, s98
    v_perm_b32 v77, v173, v169, s99
    v_perm_b32 v81, v174, v170, s98
    v_perm_b32 v85, v174, v170, s99
    v_perm_b32 v89, v175, v171, s98
    v_perm_b32 v93, v175, v171, s99
    s_waitcnt vmcnt(18)
    v_perm_b32 v66, v180, v176, s98
    v_perm_b32 v70, v180, v176, s99
    v_perm_b32 v74, v181, v177, s98
    v_perm_b32 v78, v181, v177, s99
    v_perm_b32 v82, v182, v178, s98
    v_perm_b32 v86, v182, v178, s99
    v_perm_b32 v90, v183, v179, s98
    v_perm_b32 v94, v183, v179, s99
    s_waitcnt vmcnt(16)
    v_perm_b32 v67, v188, v184, s98
    v_perm_b32 v71, v188, v184, s99
    v_perm_b32 v75, v189, v185, s98
    v_perm_b32 v79, v189, v185, s99
    v_perm_b32 v83, v190, v186, s98
    v_perm_b32 v87, v190, v186, s99
    v_perm_b32 v91, v191, v187, s98
    v_perm_b32 v95, v191, v187, s99
    s_waitcnt lgkmcnt(0)
    ds_read_b128 v[96:99], v16 offset:2048
    ds_read_b128 v[100:103], v17 offset:2048
    ds_read_b128 v[104:107], v18 offset:2048
    ds_read_b128 v[108:111], v19 offset:2048
    ds_read_b128 v[112:115], v20 offset:2048
    ds_read_b128 v[116:119], v21 offset:2048
    ds_read_b128 v[120:123], v22 offset:2048
    ds_read_b128 v[124:127], v23 offset:2048
    v_mfma_f32_16x16x32_bf16 v[28:31], v[64:67], v[32:35], v[28:31]
    v_mfma_f32_16x16x32_bf16 v[28:31], v[68:71], v[36:39], v[28:31]
    v_mfma_f32_16x16x32_bf16 v[28:31], v[72:75], v[40:43], v[28:31]
    v_mfma_f32_16x16x32_bf16 v[28:31], v[76:79], v[44:47], v[28:31]
    v_mfma_f32_16x16x32_bf16 v[28:31], v[80:83], v[48:51], v[28:31]
    v_mfma_f32_16x16x32_bf16 v[28:31], v[84:87], v[52:55], v[28:31]
    v_mfma_f32_16x16x32_bf16 v[28:31], v[88:91], v[56:59], v[28:31]
    v_mfma_f32_16x16x32_bf16 v[28:31], v[92:95], v[60:63], v[28:31]
    s_waitcnt vmcnt(14)
    v_perm_b32 v64, v196, v192, s98
    v_perm_b32 v68, v196, v192, s99
    v_perm_b32 v72, v197, v193, s98
    v_perm_b32 v76, v197, v193, s99
    v_perm_b32 v80, v198, v194, s98
    v_perm_b32 v84, v198, v194, s99
    v_perm_b32 v88, v199, v195, s98
    v_perm_b32 v92, v199, v195, s99
    s_waitcnt vmcnt(12)
    v_perm_b32 v65, v204, v200, s98
    v_perm_b32 v69, v204, v200, s99
    v_perm_b32 v73, v205, v201, s98
    v_perm_b32 v77, v205, v201, s99
    v_perm_b32 v81, v206, v202, s98
    v_perm_b32 v85, v206, v202, s99
    v_perm_b32 v89, v207, v203, s98
    v_perm_b32 v93, v207, v203, s99
    s_waitcnt vmcnt(10)
    v_perm_b32 v66, v212, v208, s98
    v_perm_b32 v70, v212, v208, s99
    v_perm_b32 v74, v213, v209, s98
    v_perm_b32 v78, v213, v209, s99
    v_perm_b32 v82, v214, v210, s98
    v_perm_b32 v86, v214, v210, s99
    v_perm_b32 v90, v215, v211, s98
    v_perm_b32 v94, v215, v211, s99
    s_waitcnt vmcnt(8)
    v_perm_b32 v67, v220, v216, s98
    v_perm_b32 v71, v220, v216, s99
    v_perm_b32 v75, v221, v217, s98
    v_perm_b32 v79, v221, v217, s99
    v_perm_b32 v83, v222, v218, s98
    v_perm_b32 v87, v222, v218, s99
    v_perm_b32 v91, v223, v219, s98
    v_perm_b32 v95, v223, v219, s99
    s_waitcnt lgkmcnt(0)
    ds_read_b128 v[32:35], v16 offset:3072
    ds_read_b128 v[36:39], v17 offset:3072
    ds_read_b128 v[40:43], v18 offset:3072
    ds_read_b128 v[44:47], v19 offset:3072
    ds_read_b128 v[48:51], v20 offset:3072
    ds_read_b128 v[52:55], v21 offset:3072
    ds_read_b128 v[56:59], v22 offset:3072
    ds_read_b128 v[60:63], v23 offset:3072
    v_mfma_f32_16x16x32_bf16 v[28:31], v[64:67], v[96:99], v[28:31]
    v_mfma_f32_16x16x32_bf16 v[28:31], v[68:71], v[100:103], v[28:31]
    v_mfma_f32_16x16x32_bf16 v[28:31], v[72:75], v[104:107], v[28:31]
    v_mfma_f32_16x16x32_bf16 v[28:31], v[76:79], v[108:111], v[28:31]
    v_mfma_f32_16x16x32_bf16 v[28:31], v[80:83], v[112:115], v[28:31]
    v_mfma_f32_16x16x32_bf16 v[28:31], v[84:87], v[116:119], v[28:31]
    v_mfma_f32_16x16x32_bf16 v[28:31], v[88:91], v[120:123], v[28:31]
    v_mfma_f32_16x16x32_bf16 v[28:31], v[92:95], v[124:127], v[28:31]
    s_waitcnt vmcnt(6)
    v_perm_b32 v64, v228, v224, s98
    v_perm_b32 v68, v228, v224, s99
    v_perm_b32 v72, v229, v225, s98
    v_perm_b32 v76, v229, v225, s99
    v_perm_b32 v80, v230, v226, s98
    v_perm_b32 v84, v230, v226, s99
    v_perm_b32 v88, v231, v227, s98
    v_perm_b32 v92, v231, v227, s99
    s_waitcnt vmcnt(4)
    v_perm_b32 v65, v236, v232, s98
    v_perm_b32 v69, v236, v232, s99
    v_perm_b32 v73, v237, v233, s98
    v_perm_b32 v77, v237, v233, s99
    v_perm_b32 v81, v238, v234, s98
    v_perm_b32 v85, v238, v234, s99
    v_perm_b32 v89, v239, v235, s98
    v_perm_b32 v93, v239, v235, s99
    s_waitcnt vmcnt(2)
    v_perm_b32 v66, v244, v240, s98
    v_perm_b32 v70, v244, v240, s99
    v_perm_b32 v74, v245, v241, s98
    v_perm_b32 v78, v245, v241, s99
    v_perm_b32 v82, v246, v242, s98
    v_perm_b32 v86, v246, v242, s99
    v_perm_b32 v90, v247, v243, s98
    v_perm_b32 v94, v247, v243, s99
    s_waitcnt vmcnt(0)
    v_perm_b32 v67, v252, v248, s98
    v_perm_b32 v71, v252, v248, s99
    v_perm_b32 v75, v253, v249, s98
    v_perm_b32 v79, v253, v249, s99
    v_perm_b32 v83, v254, v250, s98
    v_perm_b32 v87, v254, v250, s99
    v_perm_b32 v91, v255, v251, s98
    v_perm_b32 v95, v255, v251, s99
    s_waitcnt lgkmcnt(0)
    v_mfma_f32_16x16x32_bf16 v[28:31], v[64:67], v[32:35], v[28:31]
    v_mfma_f32_16x16x32_bf16 v[28:31], v[68:71], v[36:39], v[28:31]
    v_mfma_f32_16x16x32_bf16 v[28:31], v[72:75], v[40:43], v[28:31]
    v_mfma_f32_16x16x32_bf16 v[28:31], v[76:79], v[44:47], v[28:31]
    v_mfma_f32_16x16x32_bf16 v[28:31], v[80:83], v[48:51], v[28:31]
    v_mfma_f32_16x16x32_bf16 v[28:31], v[84:87], v[52:55], v[28:31]
    v_mfma_f32_16x16x32_bf16 v[28:31], v[88:91], v[56:59], v[28:31]
    v_mfma_f32_16x16x32_bf16 v[28:31], v[92:95], v[60:63], v[28:31]
    s_nop 7
    v_mul_f32 v28, v26, v28
    v_mul_f32 v29, v26, v29
    v_mul_f32 v30, v26, v30
    v_mul_f32 v31, v26, v31
    ds_write_b128 v15, v[28:31] offset:2304
    s_mov_b32 exec_lo, 0x1
    s_mov_b32 exec_hi, 0x0
    ds_add_rtn_u32 v6, v4, v5 offset:4
    s_mov_b64 exec, -1
    s_waitcnt lgkmcnt(0)
    v_readfirstlane_b32 s57, v6
    s_cmp_lg_u32 s57, 3
    s_nop 2
    s_cbranch_scc1 L_fin
    ds_read_b128 v[32:35], v14 offset:2304
    ds_read_b128 v[36:39], v14 offset:3328
    ds_read_b128 v[40:43], v14 offset:4352
    ds_read_b128 v[44:47], v14 offset:5376
    s_waitcnt lgkmcnt(2)
    v_add_f32 v32, v32, v36
    v_add_f32 v33, v33, v37
    v_add_f32 v34, v34, v38
    v_add_f32 v35, v35, v39
    s_waitcnt lgkmcnt(0)
    v_add_f32 v40, v40, v44
    v_add_f32 v41, v41, v45
    v_add_f32 v42, v42, v46
    v_add_f32 v43, v43, v47
    v_add_f32 v32, v32, v40
    v_add_f32 v33, v33, v41
    v_add_f32 v34, v34, v42
    v_add_f32 v35, v35, v43
    v_cvt_pk_bf16_f32 v36, v32, v33
    v_cvt_pk_bf16_f32 v37, v34, v35
    v_min_u32 v36, -2, v36
    v_min_u32 v37, -2, v37
    s_cmp_eq_u32 s96, 0
    s_cbranch_scc1 L_sg_7
    buffer_store_dwordx2 v[36:37], v12, s[36:39], s58 offen
    buffer_store_dwordx4 v[8:11], v13, s[36:39], s59 offen
    s_nop 0
    s_branch L_sd_8
L_sg_7:
    buffer_store_dwordx2 v[36:37], v12, s[36:39], s58 offen sc1
    buffer_store_dwordx4 v[8:11], v13, s[36:39], s59 offen sc1
    s_nop 1
L_sd_8:
    s_mov_b32 exec_lo, 0x1
    s_mov_b32 exec_hi, 0x0
    ds_add_u32 v4, v5 offset:4
    s_branch L_fin
L_kwave:
    s_mov_b32 s98, 0x05040100
    s_mov_b32 s99, 0x07060302
    s_mov_b32 s100, 0xffff0000
    s_setprio 3
    s_mov_b32 s40, s26
    s_mov_b32 s41, s27
    s_mov_b32 s42, 256
    s_mov_b32 s43, 0x20000
    v_lshlrev_b32 v10, 5, v1
    buffer_load_dword v16, v10, s[40:43], 0 offen sc1
    v_mov_b32 v4, 0
    v_mov_b32 v5, 1
    v_and_b32 v18, 1, v1
    v_lshlrev_b32 v18, 8, v18
    v_lshl_add_u32 v18, v3, 4, v18
    s_mov_b32 s58, 0x3db504f3
    s_waitcnt lgkmcnt(0)
    s_add_u32 s30, s30, 1
    s_mov_b32 s97, 0
    s_waitcnt vmcnt(9)
    s_branch L_qchk
L_qpoll:
    buffer_load_dwordx4 v[112:115], v7, s[36:39], s59 offen sc1
    buffer_load_dwordx4 v[116:119], v13, s[36:39], s59 offen sc1
    s_add_u32 s97, s97, 1
    s_waitcnt vmcnt(0)
L_qchk:
    v_xor_b32 v8, s30, v113
    v_xor_b32 v9, s30, v115
    v_xor_b32 v10, s30, v117
    v_xor_b32 v11, s30, v119
    v_or3_b32 v8, v8, v9, v10
    v_or_b32 v8, v8, v11
    v_cmp_ne_u32 vcc, 0, v8
    s_nop 0
    s_cbranch_vccz L_qok
    s_cmp_lt_u32 s97, 131072
    s_cbranch_scc1 L_qpoll
L_qok:
    v_add_f32 v8, v112, v116
    v_add_f32 v9, v114, v118
    v_mov_b32 v10, v8
    v_mov_b32 v11, v9
    s_nop 0
    v_permlane32_swap_b32 v8, v10
    v_permlane32_swap_b32 v9, v11
    v_add_f32 v8, v8, v10
    v_add_f32 v9, v9, v11
    v_cvt_pk_bf16_f32 v8, v8, v9
    ds_write_b32 v17, v8 offset:128
    s_waitcnt lgkmcnt(0)
    s_mov_b32 exec_lo, 0x1
    s_mov_b32 exec_hi, 0x0
    ds_add_u32 v4, v5 offset:12
    s_mov_b64 exec, -1
    s_mov_b32 s97, 0
L_spin_9:
    ds_read_b32 v12, v4 offset:12
    s_add_u32 s97, s97, 1
    s_waitcnt lgkmcnt(0)
    v_readfirstlane_b32 s57, v12
    s_cmp_ge_u32 s97, 1048576
    s_nop 2
    s_cbranch_scc1 L_spd_10
    s_cmp_lt_u32 s57, 4
    s_cbranch_scc1 L_spin_9
L_spd_10:
    ds_read_b128 v[96:99], v18 offset:128
    ds_read_b128 v[100:103], v18 offset:192
    ds_read_b128 v[104:107], v18 offset:256
    ds_read_b128 v[108:111], v18 offset:320
    s_waitcnt lgkmcnt(0)
    v_mfma_f32_16x16x32_bf16 v[64:67], v[128:131], v[96:99], 0
    v_mfma_f32_16x16x32_bf16 v[64:67], v[132:135], v[100:103], v[64:67]
    v_mfma_f32_16x16x32_bf16 v[64:67], v[136:139], v[104:107], v[64:67]
    v_mfma_f32_16x16x32_bf16 v[64:67], v[140:143], v[108:111], v[64:67]
    v_mfma_f32_16x16x32_bf16 v[68:71], v[144:147], v[96:99], 0
    v_mfma_f32_16x16x32_bf16 v[68:71], v[148:151], v[100:103], v[68:71]
    v_mfma_f32_16x16x32_bf16 v[68:71], v[152:155], v[104:107], v[68:71]
    v_mfma_f32_16x16x32_bf16 v[68:71], v[156:159], v[108:111], v[68:71]
    s_nop 3
    v_cvt_pk_bf16_f32 v12, v64, v65
    v_cvt_pk_bf16_f32 v13, v66, v67
    v_lshlrev_b32 v64, 16, v12
    v_and_b32 v65, s100, v12
    v_lshlrev_b32 v66, 16, v13
    v_and_b32 v67, s100, v13
    v_mul_f32 v64, s58, v64
    v_mul_f32 v65, s58, v65
    v_mul_f32 v66, s58, v66
    v_mul_f32 v67, s58, v67
    v_cvt_pk_bf16_f32 v12, v64, v65
    v_cvt_pk_bf16_f32 v13, v66, v67
    v_lshlrev_b32 v64, 16, v12
    v_and_b32 v65, s100, v12
    v_lshlrev_b32 v66, 16, v13
    v_and_b32 v67, s100, v13
    v_max_f32 v8, v64, v65
    v_max_f32 v9, v66, v67
    v_mfma_f32_16x16x32_bf16 v[72:75], v[160:163], v[96:99], 0
    v_mfma_f32_16x16x32_bf16 v[72:75], v[164:167], v[100:103], v[72:75]
    v_mfma_f32_16x16x32_bf16 v[72:75], v[168:171], v[104:107], v[72:75]
    v_mfma_f32_16x16x32_bf16 v[72:75], v[172:175], v[108:111], v[72:75]
    v_cvt_pk_bf16_f32 v12, v68, v69
    v_cvt_pk_bf16_f32 v13, v70, v71
    v_lshlrev_b32 v68, 16, v12
    v_and_b32 v69, s100, v12
    v_lshlrev_b32 v70, 16, v13
    v_and_b32 v71, s100, v13
    v_mul_f32 v68, s58, v68
    v_mul_f32 v69, s58, v69
    v_mul_f32 v70, s58, v70
    v_mul_f32 v71, s58, v71
    v_cvt_pk_bf16_f32 v12, v68, v69
    v_cvt_pk_bf16_f32 v13, v70, v71
    v_lshlrev_b32 v68, 16, v12
    v_and_b32 v69, s100, v12
    v_lshlrev_b32 v70, 16, v13
    v_and_b32 v71, s100, v13
    v_max3_f32 v8, v68, v69, v8
    v_max3_f32 v9, v70, v71, v9
    v_mfma_f32_16x16x32_bf16 v[76:79], v[176:179], v[96:99], 0
    v_mfma_f32_16x16x32_bf16 v[76:79], v[180:183], v[100:103], v[76:79]
    v_mfma_f32_16x16x32_bf16 v[76:79], v[184:187], v[104:107], v[76:79]
    v_mfma_f32_16x16x32_bf16 v[76:79], v[188:191], v[108:111], v[76:79]
    v_cvt_pk_bf16_f32 v12, v72, v73
    v_cvt_pk_bf16_f32 v13, v74, v75
    v_lshlrev_b32 v72, 16, v12
    v_and_b32 v73, s100, v12
    v_lshlrev_b32 v74, 16, v13
    v_and_b32 v75, s100, v13
    v_mul_f32 v72, s58, v72
    v_mul_f32 v73, s58, v73
    v_mul_f32 v74, s58, v74
    v_mul_f32 v75, s58, v75
    v_cvt_pk_bf16_f32 v12, v72, v73
    v_cvt_pk_bf16_f32 v13, v74, v75
    v_lshlrev_b32 v72, 16, v12
    v_and_b32 v73, s100, v12
    v_lshlrev_b32 v74, 16, v13
    v_and_b32 v75, s100, v13
    v_max3_f32 v8, v72, v73, v8
    v_max3_f32 v9, v74, v75, v9
    v_mfma_f32_16x16x32_bf16 v[80:83], v[192:195], v[96:99], 0
    v_mfma_f32_16x16x32_bf16 v[80:83], v[196:199], v[100:103], v[80:83]
    v_mfma_f32_16x16x32_bf16 v[80:83], v[200:203], v[104:107], v[80:83]
    v_mfma_f32_16x16x32_bf16 v[80:83], v[204:207], v[108:111], v[80:83]
    v_cvt_pk_bf16_f32 v12, v76, v77
    v_cvt_pk_bf16_f32 v13, v78, v79
    v_lshlrev_b32 v76, 16, v12
    v_and_b32 v77, s100, v12
    v_lshlrev_b32 v78, 16, v13
    v_and_b32 v79, s100, v13
    v_mul_f32 v76, s58, v76
    v_mul_f32 v77, s58, v77
    v_mul_f32 v78, s58, v78
    v_mul_f32 v79, s58, v79
    v_cvt_pk_bf16_f32 v12, v76, v77
    v_cvt_pk_bf16_f32 v13, v78, v79
    v_lshlrev_b32 v76, 16, v12
    v_and_b32 v77, s100, v12
    v_lshlrev_b32 v78, 16, v13
    v_and_b32 v79, s100, v13
    v_max3_f32 v8, v76, v77, v8
    v_max3_f32 v9, v78, v79, v9
    v_mfma_f32_16x16x32_bf16 v[84:87], v[208:211], v[96:99], 0
    v_mfma_f32_16x16x32_bf16 v[84:87], v[212:215], v[100:103], v[84:87]
    v_mfma_f32_16x16x32_bf16 v[84:87], v[216:219], v[104:107], v[84:87]
    v_mfma_f32_16x16x32_bf16 v[84:87], v[220:223], v[108:111], v[84:87]
    v_cvt_pk_bf16_f32 v12, v80, v81
    v_cvt_pk_bf16_f32 v13, v82, v83
    v_lshlrev_b32 v80, 16, v12
    v_and_b32 v81, s100, v12
    v_lshlrev_b32 v82, 16, v13
    v_and_b32 v83, s100, v13
    v_mul_f32 v80, s58, v80
    v_mul_f32 v81, s58, v81
    v_mul_f32 v82, s58, v82
    v_mul_f32 v83, s58, v83
    v_cvt_pk_bf16_f32 v12, v80, v81
    v_cvt_pk_bf16_f32 v13, v82, v83
    v_lshlrev_b32 v80, 16, v12
    v_and_b32 v81, s100, v12
    v_lshlrev_b32 v82, 16, v13
    v_and_b32 v83, s100, v13
    v_max3_f32 v8, v80, v81, v8
    v_max3_f32 v9, v82, v83, v9
    s_waitcnt vmcnt(5)
    v_mfma_f32_16x16x32_bf16 v[88:91], v[224:227], v[96:99], 0
    v_mfma_f32_16x16x32_bf16 v[88:91], v[228:231], v[100:103], v[88:91]
    v_mfma_f32_16x16x32_bf16 v[88:91], v[232:235], v[104:107], v[88:91]
    v_mfma_f32_16x16x32_bf16 v[88:91], v[236:239], v[108:111], v[88:91]
    v_cvt_pk_bf16_f32 v12, v84, v85
    v_cvt_pk_bf16_f32 v13, v86, v87
    v_lshlrev_b32 v84, 16, v12
    v_and_b32 v85, s100, v12
    v_lshlrev_b32 v86, 16, v13
    v_and_b32 v87, s100, v13
    v_mul_f32 v84, s58, v84
    v_mul_f32 v85, s58, v85
    v_mul_f32 v86, s58, v86
    v_mul_f32 v87, s58, v87
    v_cvt_pk_bf16_f32 v12, v84, v85
    v_cvt_pk_bf16_f32 v13, v86, v87
    v_lshlrev_b32 v84, 16, v12
    v_and_b32 v85, s100, v12
    v_lshlrev_b32 v86, 16, v13
    v_and_b32 v87, s100, v13
    v_max3_f32 v8, v84, v85, v8
    v_max3_f32 v9, v86, v87, v9
    s_waitcnt vmcnt(0)
    v_mfma_f32_16x16x32_bf16 v[92:95], v[240:243], v[96:99], 0
    v_mfma_f32_16x16x32_bf16 v[92:95], v[244:247], v[100:103], v[92:95]
    v_mfma_f32_16x16x32_bf16 v[92:95], v[248:251], v[104:107], v[92:95]
    v_mfma_f32_16x16x32_bf16 v[92:95], v[252:255], v[108:111], v[92:95]
    v_cvt_pk_bf16_f32 v12, v88, v89
    v_cvt_pk_bf16_f32 v13, v90, v91
    v_lshlrev_b32 v88, 16, v12
    v_and_b32 v89, s100, v12
    v_lshlrev_b32 v90, 16, v13
    v_and_b32 v91, s100, v13
    v_mul_f32 v88, s58, v88
    v_mul_f32 v89, s58, v89
    v_mul_f32 v90, s58, v90
    v_mul_f32 v91, s58, v91
    v_cvt_pk_bf16_f32 v12, v88, v89
    v_cvt_pk_bf16_f32 v13, v90, v91
    v_lshlrev_b32 v88, 16, v12
    v_and_b32 v89, s100, v12
    v_lshlrev_b32 v90, 16, v13
    v_and_b32 v91, s100, v13
    v_max3_f32 v8, v88, v89, v8
    v_max3_f32 v9, v90, v91, v9
    v_cvt_pk_bf16_f32 v12, v92, v93
    v_cvt_pk_bf16_f32 v13, v94, v95
    v_lshlrev_b32 v92, 16, v12
    v_and_b32 v93, s100, v12
    v_lshlrev_b32 v94, 16, v13
    v_and_b32 v95, s100, v13
    v_mul_f32 v92, s58, v92
    v_mul_f32 v93, s58, v93
    v_mul_f32 v94, s58, v94
    v_mul_f32 v95, s58, v95
    v_cvt_pk_bf16_f32 v12, v92, v93
    v_cvt_pk_bf16_f32 v13, v94, v95
    v_lshlrev_b32 v92, 16, v12
    v_and_b32 v93, s100, v12
    v_lshlrev_b32 v94, 16, v13
    v_and_b32 v95, s100, v13
    v_max3_f32 v8, v92, v93, v8
    v_max3_f32 v9, v94, v95, v9
    v_max_f32 v8, v8, v9
    v_mov_b32 v9, v8
    s_nop 1
    v_permlane16_swap_b32 v8, v9
    v_max_f32 v8, v8, v9
    v_mov_b32 v9, v8
    s_nop 1
    v_permlane32_swap_b32 v8, v9
    v_max_f32 v8, v8, v9
    s_mov_b32 s57, 0x3fb8aa3b
    v_sub_f32 v64, v64, v8
    v_sub_f32 v65, v65, v8
    v_sub_f32 v66, v66, v8
    v_sub_f32 v67, v67, v8
    v_sub_f32 v68, v68, v8
    v_sub_f32 v69, v69, v8
    v_sub_f32 v70, v70, v8
    v_sub_f32 v71, v71, v8
    v_sub_f32 v72, v72, v8
    v_sub_f32 v73, v73, v8
    v_sub_f32 v74, v74, v8
    v_sub_f32 v75, v75, v8
    v_sub_f32 v76, v76, v8
    v_sub_f32 v77, v77, v8
    v_sub_f32 v78, v78, v8
    v_sub_f32 v79, v79, v8
    v_sub_f32 v80, v80, v8
    v_sub_f32 v81, v81, v8
    v_sub_f32 v82, v82, v8
    v_sub_f32 v83, v83, v8
    v_sub_f32 v84, v84, v8
    v_sub_f32 v85, v85, v8
    v_sub_f32 v86, v86, v8
    v_sub_f32 v87, v87, v8
    v_sub_f32 v88, v88, v8
    v_sub_f32 v89, v89, v8
    v_sub_f32 v90, v90, v8
    v_sub_f32 v91, v91, v8
    v_sub_f32 v92, v92, v8
    v_sub_f32 v93, v93, v8
    v_sub_f32 v94, v94, v8
    v_sub_f32 v95, v95, v8
    v_mul_f32 v64, s57, v64
    v_mul_f32 v65, s57, v65
    v_mul_f32 v66, s57, v66
    v_mul_f32 v67, s57, v67
    v_mul_f32 v68, s57, v68
    v_mul_f32 v69, s57, v69
    v_mul_f32 v70, s57, v70
    v_mul_f32 v71, s57, v71
    v_mul_f32 v72, s57, v72
    v_mul_f32 v73, s57, v73
    v_mul_f32 v74, s57, v74
    v_mul_f32 v75, s57, v75
    v_mul_f32 v76, s57, v76
    v_mul_f32 v77, s57, v77
    v_mul_f32 v78, s57, v78
    v_mul_f32 v79, s57, v79
    v_mul_f32 v80, s57, v80
    v_mul_f32 v81, s57, v81
    v_mul_f32 v82, s57, v82
    v_mul_f32 v83, s57, v83
    v_mul_f32 v84, s57, v84
    v_mul_f32 v85, s57, v85
    v_mul_f32 v86, s57, v86
    v_mul_f32 v87, s57, v87
    v_mul_f32 v88, s57, v88
    v_mul_f32 v89, s57, v89
    v_mul_f32 v90, s57, v90
    v_mul_f32 v91, s57, v91
    v_mul_f32 v92, s57, v92
    v_mul_f32 v93, s57, v93
    v_mul_f32 v94, s57, v94
    v_mul_f32 v95, s57, v95
    v_exp_f32 v64, v64
    v_exp_f32 v65, v65
    v_exp_f32 v66, v66
    v_exp_f32 v67, v67
    v_exp_f32 v68, v68
    v_exp_f32 v69, v69
    v_exp_f32 v70, v70
    v_exp_f32 v71, v71
    v_exp_f32 v72, v72
    v_exp_f32 v73, v73
    v_exp_f32 v74, v74
    v_exp_f32 v75, v75
    v_exp_f32 v76, v76
    v_exp_f32 v77, v77
    v_exp_f32 v78, v78
    v_exp_f32 v79, v79
    v_exp_f32 v80, v80
    v_exp_f32 v81, v81
    v_exp_f32 v82, v82
    v_exp_f32 v83, v83
    v_exp_f32 v84, v84
    v_exp_f32 v85, v85
    v_exp_f32 v86, v86
    v_exp_f32 v87, v87
    v_exp_f32 v88, v88
    v_exp_f32 v89, v89
    v_exp_f32 v90, v90
    v_exp_f32 v91, v91
    v_exp_f32 v92, v92
    v_exp_f32 v93, v93
    v_exp_f32 v94, v94
    v_exp_f32 v95, v95
    v_cvt_pk_bf16_f32 v96, v64, v65
    v_cvt_pk_bf16_f32 v97, v66, v67
    v_cvt_pk_bf16_f32 v98, v68, v69
    v_cvt_pk_bf16_f32 v99, v70, v71
    v_cvt_pk_bf16_f32 v100, v72, v73
    v_cvt_pk_bf16_f32 v101, v74, v75
    v_cvt_pk_bf16_f32 v102, v76, v77
    v_cvt_pk_bf16_f32 v103, v78, v79
    v_cvt_pk_bf16_f32 v104, v80, v81
    v_cvt_pk_bf16_f32 v105, v82, v83
    v_cvt_pk_bf16_f32 v106, v84, v85
    v_cvt_pk_bf16_f32 v107, v86, v87
    v_cvt_pk_bf16_f32 v108, v88, v89
    v_cvt_pk_bf16_f32 v109, v90, v91
    v_cvt_pk_bf16_f32 v110, v92, v93
    v_cvt_pk_bf16_f32 v111, v94, v95
    s_lshl_b32 s57, s49, 12
    v_lshl_add_u32 v10, v1, 4, s57
    v_mov_b32 v12, 0
    v_mov_b32 v13, 0
    v_mov_b32 v14, 0
    v_mov_b32 v15, 0
    s_mov_b32 exec_lo, 0x30003
    s_mov_b32 exec_hi, 0x30003
    ds_write_b128 v10, v[96:99] offset:6400
    ds_write_b128 v10, v[100:103] offset:7424
    ds_write_b128 v10, v[104:107] offset:8448
    ds_write_b128 v10, v[108:111] offset:9472
    s_mov_b32 exec_lo, 0x40004
    s_mov_b32 exec_hi, 0x40004
    ds_write_b128 v10, v[12:15] offset:6400
    ds_write_b128 v10, v[12:15] offset:7424
    ds_write_b128 v10, v[12:15] offset:8448
    ds_write_b128 v10, v[12:15] offset:9472
    s_mov_b64 exec, -1
    v_pk_add_f32 v[64:65], v[64:65], v[80:81]
    v_pk_add_f32 v[66:67], v[66:67], v[82:83]
    v_pk_add_f32 v[68:69], v[68:69], v[84:85]
    v_pk_add_f32 v[70:71], v[70:71], v[86:87]
    v_pk_add_f32 v[72:73], v[72:73], v[88:89]
    v_pk_add_f32 v[74:75], v[74:75], v[90:91]
    v_pk_add_f32 v[76:77], v[76:77], v[92:93]
    v_pk_add_f32 v[78:79], v[78:79], v[94:95]
    v_pk_add_f32 v[64:65], v[64:65], v[72:73]
    v_pk_add_f32 v[66:67], v[66:67], v[74:75]
    v_pk_add_f32 v[68:69], v[68:69], v[76:77]
    v_pk_add_f32 v[70:71], v[70:71], v[78:79]
    v_pk_add_f32 v[64:65], v[64:65], v[68:69]
    v_pk_add_f32 v[66:67], v[66:67], v[70:71]
    v_pk_add_f32 v[64:65], v[64:65], v[66:67]
    v_add_f32 v9, v64, v65
    v_mov_b32 v10, v9
    s_nop 1
    v_permlane16_swap_b32 v9, v10
    v_add_f32 v9, v9, v10
    v_mov_b32 v10, v9
    s_nop 1
    v_permlane32_swap_b32 v9, v10
    v_add_f32 v9, v9, v10
    s_lshl_b32 s57, s49, 4
    v_lshl_add_u32 v11, v1, 3, s57
    s_mov_b32 exec_lo, 0x3
    s_mov_b32 exec_hi, 0x0
    ds_write_b64 v11, v[8:9] offset:64
    s_waitcnt lgkmcnt(0)
    s_mov_b32 exec_lo, 0x1
    s_mov_b32 exec_hi, 0x0
    ds_add_u32 v4, v5 offset:16
    s_mov_b64 exec, -1
    s_cmp_lg_u32 s49, 0
    s_cbranch_scc1 L_kb1
    v_lshlrev_b32 v10, 5, v1
    s_getreg_b32 s57, hwreg(HW_REG_XCC_ID, 0, 4)
    s_mul_i32 s58, s57, s57
    s_lshl_b32 s58, s58, 16
    s_lshl_b32 s57, s57, 8
    s_add_u32 s57, s57, s58
    s_add_u32 s57, s57, 1
    s_lshl_b32 s58, s57, 5
    s_mov_b32 s97, 0
    s_branch L_cchk
L_cpoll:
    buffer_load_dword v16, v10, s[40:43], 0 offen sc1
L_cchk:
    s_add_u32 s97, s97, 1
    s_waitcnt vmcnt(0)
    v_and_b32 v12, 63, v16
    v_cmp_ne_u32 vcc, 32, v12
    s_and_b32 s57, vcc_lo, 0xff
    s_cbranch_scc0 L_cok
    s_cmp_lt_u32 s97, 131072
    s_cbranch_scc1 L_cpoll
L_cok:
    v_readlane_b32 s57, v16, s50
    s_cmp_eq_u32 s57, s58
    s_cselect_b32 s57, 2, 1
    v_mov_b32 v11, s57
    ds_write_b32 v4, v11 offset:8
    s_nop 0
L_kb1:
    s_setprio 0
    s_cmp_lt_u32 s51, 18
    s_cbranch_scc1 L_ffn
    s_cmp_ge_u32 s51, 27
    s_cbranch_scc1 L_spare
    s_sub_u32 s61, s51, 18
    s_mov_b32 s40, s12
    s_mov_b32 s41, s13
    s_mov_b32 s42, 4718592
    s_mov_b32 s43, 0x20000
    s_mov_b32 s44, s4
    s_mov_b32 s45, s5
    s_mov_b32 s46, 9216
    s_mov_b32 s47, 0x20000
    v_lshrrev_b32 v6, 3, v1
    v_mul_u32_u24 v6, 1152, v6
    v_bfe_u32 v7, v1, 4, 1
    v_lshlrev_b32 v7, 1, v7
    v_and_b32 v8, 7, v1
    v_xor_b32 v7, v7, v8
    v_lshl_add_u32 v6, v7, 4, v6
    v_bfe_u32 v7, v1, 4, 1
    s_lshl_b32 s57, s49, 1
    v_add_u32 v7, s57, v7
    v_mul_u32_u24 v7, 1152, v7
    v_lshl_add_u32 v7, v2, 3, v7
    s_lshl_b32 s57, s61, 7
    buffer_load_dwordx2 v[20:21], v7, s[44:47], s57 offen
    v_mov_b32 v8, 0x7ffffff0
    v_cmp_gt_u32 vcc, 32, v1
    s_nop 1
    v_cndmask_b32 v22, v8, v7, vcc
    s_mul_i32 s62, s50, 9216
    s_add_u32 s62, s62, s57
    s_add_u32 s62, s62, 835584
    s_mul_i32 s60, s49, 17408
    s_add_u32 s60, s60, 25600
    v_bfe_u32 v8, v1, 2, 2
    v_mul_u32_u24 v8, 4160, v8
    v_lshl_add_u32 v8, v3, 8, v8
    v_and_b32 v9, 3, v1
    v_lshl_add_u32 v8, v9, 3, v8
    v_add_u32 v8, s60, v8
    v_and_b32 v9, 1, v3
    v_lshl_add_u32 v10, v9, 5, v8
    v_xor_b32 v9, 1, v9
    v_lshl_add_u32 v11, v9, 5, v8
    v_lshrrev_b32 v13, 2, v1
    v_lshlrev_b32 v13, 8, v13
    v_and_b32 v14, 3, v1
    v_lshl_add_u32 v13, v14, 4, v13
    v_lshlrev_b32 v54, 4, v2
    v_lshl_add_u32 v54, v3, 2, v54
    v_lshlrev_b32 v55, 2, v2
    v_mov_b32 v56, 0
    v_mov_b32 v57, 0
    v_lshlrev_b32 v14, 7, v2
    s_lshl_b32 s11, s50, 14
    s_lshl_b32 s57, s49, 12
    s_add_u32 s11, s11, s57
    s_add_u32 s11, s11, 524288
    s_lshl_b32 s14, s50, 12
    s_lshr_b32 s57, s49, 1
    s_lshl_b32 s57, s57, 11
    s_add_u32 s14, s14, s57
    s_and_b32 s57, s49, 1
    s_lshl_b32 s57, s57, 3
    s_add_u32 s14, s14, s57
    s_add_u32 s14, s14, 655360
    v_mul_u32_u24 v15, 272, v2
    v_lshl_add_u32 v15, v3, 4, v15
    s_mul_i32 s57, s49, 2176
    s_add_u32 s57, s57, 132096
    v_add_u32 v15, s57, v15
    v_bfe_u32 v16, v1, 4, 1
    s_lshl_b32 s57, s49, 1
    v_add_u32 v16, s57, v16
    v_mul_u32_u24 v16, 272, v16
    v_lshl_add_u32 v16, v2, 4, v16
    v_lshrrev_b32 v17, 5, v1
    v_mul_u32_u24 v17, 4352, v17
    v_add_u32 v16, v16, v17
    v_add_u32 v16, 132096, v16
    v_and_b32 v17, 31, v1
    v_lshlrev_b32 v17, 4, v17
    v_mov_b32 v8, 0x7ffffff0
    v_cmp_gt_u32 vcc, 32, v1
    s_nop 1
    v_cndmask_b32 v18, v8, v17, vcc
    v_lshrrev_b32 v19, 5, v1
    v_lshl_add_u32 v19, v19, 13, v17
    v_add_u32 v23, 4096, v19
    v_lshrrev_b32 v46, 5, v1
    v_lshlrev_b32 v46, 2, v46
    v_add_u32 v47, 0, v46
    v_cmp_ne_u32 vcc, s50, v47
    v_add_u32 v47, 0, v19
    s_nop 0
    v_cndmask_b32 v48, v8, v47, vcc
    v_add_u32 v47, 1, v46
    v_cmp_ne_u32 vcc, s50, v47
    v_add_u32 v47, 2048, v19
    s_nop 0
    v_cndmask_b32 v49, v8, v47, vcc
    v_add_u32 v47, 2, v46
    v_cmp_ne_u32 vcc, s50, v47
    v_add_u32 v47, 4096, v19
    s_nop 0
    v_cndmask_b32 v50, v8, v47, vcc
    v_add_u32 v47, 3, v46
    v_cmp_ne_u32 vcc, s50, v47
    v_add_u32 v47, 6144, v19
    s_nop 0
    v_cndmask_b32 v51, v8, v47, vcc
    s_lshl_b32 s63, s61, 14
    s_lshl_b32 s57, s49, 9
    s_add_u32 s63, s63, s57
    s_add_u32 s63, s63, 688128
    s_lshl_b32 s57, s50, 11
    s_add_u32 s15, s63, s57
    s_mov_b32 s101, s61
    v_lshrrev_b32 v40, 3, v1
    v_mul_u32_u24 v40, 1152, v40
    v_bfe_u32 v41, v1, 4, 1
    v_lshlrev_b32 v41, 1, v41
    v_and_b32 v42, 7, v1
    v_xor_b32 v41, v41, v42
    s_and_b32 s57, s49, 1
    s_lshl_b32 s57, s57, 2
    v_xor_b32 v41, s57, v41
    v_xor_b32 v42, 4, v41
    v_lshl_add_u32 v41, v41, 4, v40
    v_lshl_add_u32 v40, v42, 4, v40
    v_bfe_u32 v43, v1, 2, 2
    v_lshl_add_u32 v43, v3, 3, v43
    v_lshlrev_b32 v42, 7, v43
    v_bfe_u32 v43, v1, 3, 2
    v_xor_b32 v43, s49, v43
    v_lshl_add_u32 v42, v43, 5, v42
    v_and_b32 v43, 3, v1
    v_lshl_add_u32 v42, v43, 3, v42
    v_add_u32 v42, 95232, v42
    v_and_b32 v44, 7, v1
    v_lshlrev_b32 v43, 4, v44
    v_lshl_add_u32 v43, v3, 7, v43
    v_mov_b32 v45, 0x7ffffff0
    v_cmp_gt_u32 vcc, 8, v2
    s_nop 1
    v_cndmask_b32 v58, v45, v43, vcc
    v_bfe_u32 v45, v1, 3, 1
    v_mul_u32_u24 v45, 2560, v45
    v_add_u32 v43, v43, v45
    v_lshlrev_b32 v44, 6, v44
    v_lshl_add_u32 v44, v3, 4, v44
    v_mov_b32 v45, 0x7ffffff0
    v_cmp_gt_u32 vcc, 8, v2
    s_nop 1
    v_cndmask_b32 v44, v45, v44, vcc
    s_mul_i32 s6, s50, 576
    s_mul_i32 s57, s49, 72
    s_add_u32 s6, s6, s57
    s_add_u32 s6, s6, 0
    s_mul_i32 s6, s6, 1152
    s_lshl_b32 s57, s101, 7
    s_add_u32 s6, s6, s57
    s_mul_i32 s7, s49, 9216
    s_add_u32 s7, s7, 95232
    s_mul_i32 s8, s50, 9216
    s_add_u32 s8, s8, 909312
    s_add_u32 s9, s8, 4096
    s_lshl_b32 s10, s101, 15
    s_lshl_b32 s57, s50, 10
    s_add_u32 s10, s10, s57
    s_lshl_b32 s57, s49, 13
    s_add_u32 s10, s10, s57
    s_add_u32 s10, s10, 1056768
    s_lshl_b32 s57, s50, 2
    s_add_u32 s57, s57, s49
    s_mul_i32 s58, s57, 147456
    s_lshl_b32 s57, s61, 7
    s_add_u32 s58, s58, s57
    s_mov_b32 s97, 0
L_spin_11:
    ds_read_b32 v12, v4 offset:20
    s_add_u32 s97, s97, 1
    s_waitcnt lgkmcnt(0)
    v_readfirstlane_b32 s57, v12
    s_cmp_ge_u32 s97, 1048576
    s_nop 2
    s_cbranch_scc1 L_spd_12
    s_cmp_lt_u32 s57, 4
    s_cbranch_scc1 L_spin_11
L_spd_12:
    s_mov_b32 s96, 0
    s_add_u32 s57, s60, 0
    s_mov_b32 m0, s57
    s_add_u32 s57, s58, 0
    buffer_load_dwordx4 v6, s[40:43], s57 offen nt lds
    s_add_u32 s57, s60, 4160
    s_mov_b32 m0, s57
    s_add_u32 s57, s58, 36864
    buffer_load_dwordx4 v6, s[40:43], s57 offen nt lds
    s_add_u32 s57, s60, 8320
    s_mov_b32 m0, s57
    s_add_u32 s57, s58, 73728
    buffer_load_dwordx4 v6, s[40:43], s57 offen nt lds
    s_add_u32 s57, s60, 12480
    s_mov_b32 m0, s57
    s_add_u32 s57, s58, 110592
    buffer_load_dwordx4 v6, s[40:43], s57 offen nt lds
    s_cmp_eq_u32 s96, 1
    s_cbranch_scc1 L_thr_13
    ds_read_b32 v12, v4 offset:4
    s_waitcnt vmcnt(3) lgkmcnt(0)
    v_readfirstlane_b32 s96, v12
    s_cmp_ge_u32 s96, 5
    s_cselect_b32 s96, 1, 0
    s_nop 2
L_thr_13:
    s_add_u32 s57, s60, 1040
    s_mov_b32 m0, s57
    s_add_u32 s57, s58, 9216
    buffer_load_dwordx4 v6, s[40:43], s57 offen nt lds
    s_cmp_eq_u32 s96, 1
    s_cbranch_scc1 L_thr_14
    ds_read_b32 v12, v4 offset:4
    s_waitcnt vmcnt(3) lgkmcnt(0)
    v_readfirstlane_b32 s96, v12
    s_cmp_ge_u32 s96, 5
    s_cselect_b32 s96, 1, 0
    s_nop 2
L_thr_14:
    s_add_u32 s57, s60, 5200
    s_mov_b32 m0, s57
    s_add_u32 s57, s58, 46080
    buffer_load_dwordx4 v6, s[40:43], s57 offen nt lds
    s_cmp_eq_u32 s96, 1
    s_cbranch_scc1 L_thr_15
    ds_read_b32 v12, v4 offset:4
    s_waitcnt vmcnt(3) lgkmcnt(0)
    v_readfirstlane_b32 s96, v12
    s_cmp_ge_u32 s96, 5
    s_cselect_b32 s96, 1, 0
    s_nop 2
L_thr_15:
    s_add_u32 s57, s60, 9360
    s_mov_b32 m0, s57
    s_add_u32 s57, s58, 82944
    buffer_load_dwordx4 v6, s[40:43], s57 offen nt lds
    s_cmp_eq_u32 s96, 1
    s_cbranch_scc1 L_thr_16
    ds_read_b32 v12, v4 offset:4
    s_waitcnt vmcnt(3) lgkmcnt(0)
    v_readfirstlane_b32 s96, v12
    s_cmp_ge_u32 s96, 5
    s_cselect_b32 s96, 1, 0
    s_nop 2
L_thr_16:
    s_add_u32 s57, s60, 13520
    s_mov_b32 m0, s57
    s_add_u32 s57, s58, 119808
    buffer_load_dwordx4 v6, s[40:43], s57 offen nt lds
    s_cmp_eq_u32 s96, 1
    s_cbranch_scc1 L_thr_17
    ds_read_b32 v12, v4 offset:4
    s_waitcnt vmcnt(3) lgkmcnt(0)
    v_readfirstlane_b32 s96, v12
    s_cmp_ge_u32 s96, 5
    s_cselect_b32 s96, 1, 0
    s_nop 2
L_thr_17:
    s_add_u32 s57, s60, 2080
    s_mov_b32 m0, s57
    s_add_u32 s57, s58, 18432
    buffer_load_dwordx4 v6, s[40:43], s57 offen nt lds
    s_cmp_eq_u32 s96, 1
    s_cbranch_scc1 L_thr_18
    ds_read_b32 v12, v4 offset:4
    s_waitcnt vmcnt(3) lgkmcnt(0)
    v_readfirstlane_b32 s96, v12
    s_cmp_ge_u32 s96, 5
    s_cselect_b32 s96, 1, 0
    s_nop 2
L_thr_18:
    s_add_u32 s57, s60, 6240
    s_mov_b32 m0, s57
    s_add_u32 s57, s58, 55296
    buffer_load_dwordx4 v6, s[40:43], s57 offen nt lds
    s_cmp_eq_u32 s96, 1
    s_cbranch_scc1 L_thr_19
    ds_read_b32 v12, v4 offset:4
    s_waitcnt vmcnt(3) lgkmcnt(0)
    v_readfirstlane_b32 s96, v12
    s_cmp_ge_u32 s96, 5
    s_cselect_b32 s96, 1, 0
    s_nop 2
L_thr_19:
    s_add_u32 s57, s60, 10400
    s_mov_b32 m0, s57
    s_add_u32 s57, s58, 92160
    buffer_load_dwordx4 v6, s[40:43], s57 offen nt lds
    s_cmp_eq_u32 s96, 1
    s_cbranch_scc1 L_thr_20
    ds_read_b32 v12, v4 offset:4
    s_waitcnt vmcnt(3) lgkmcnt(0)
    v_readfirstlane_b32 s96, v12
    s_cmp_ge_u32 s96, 5
    s_cselect_b32 s96, 1, 0
    s_nop 2
L_thr_20:
    s_add_u32 s57, s60, 14560
    s_mov_b32 m0, s57
    s_add_u32 s57, s58, 129024
    buffer_load_dwordx4 v6, s[40:43], s57 offen nt lds
    s_cmp_eq_u32 s96, 1
    s_cbranch_scc1 L_thr_21
    ds_read_b32 v12, v4 offset:4
    s_waitcnt vmcnt(3) lgkmcnt(0)
    v_readfirstlane_b32 s96, v12
    s_cmp_ge_u32 s96, 5
    s_cselect_b32 s96, 1, 0
    s_nop 2
L_thr_21:
    s_add_u32 s57, s60, 3120
    s_mov_b32 m0, s57
    s_add_u32 s57, s58, 27648
    buffer_load_dwordx4 v6, s[40:43], s57 offen nt lds
    s_cmp_eq_u32 s96, 1
    s_cbranch_scc1 L_thr_22
    ds_read_b32 v12, v4 offset:4
    s_waitcnt vmcnt(3) lgkmcnt(0)
    v_readfirstlane_b32 s96, v12
    s_cmp_ge_u32 s96, 5
    s_cselect_b32 s96, 1, 0
    s_nop 2
L_thr_22:
    s_add_u32 s57, s60, 7280
    s_mov_b32 m0, s57
    s_add_u32 s57, s58, 64512
    buffer_load_dwordx4 v6, s[40:43], s57 offen nt lds
    s_cmp_eq_u32 s96, 1
    s_cbranch_scc1 L_thr_23
    ds_read_b32 v12, v4 offset:4
    s_waitcnt vmcnt(3) lgkmcnt(0)
    v_readfirstlane_b32 s96, v12
    s_cmp_ge_u32 s96, 5
    s_cselect_b32 s96, 1, 0
    s_nop 2
L_thr_23:
    s_add_u32 s57, s60, 11440
    s_mov_b32 m0, s57
    s_add_u32 s57, s58, 101376
    buffer_load_dwordx4 v6, s[40:43], s57 offen nt lds
    s_cmp_eq_u32 s96, 1
    s_cbranch_scc1 L_thr_24
    ds_read_b32 v12, v4 offset:4
    s_waitcnt vmcnt(3) lgkmcnt(0)
    v_readfirstlane_b32 s96, v12
    s_cmp_ge_u32 s96, 5
    s_cselect_b32 s96, 1, 0
    s_nop 2
L_thr_24:
    s_add_u32 s57, s60, 15600
    s_mov_b32 m0, s57
    s_add_u32 s57, s58, 138240
    buffer_load_dwordx4 v6, s[40:43], s57 offen nt lds
    s_setprio 3
    s_mov_b32 s97, 0
L_spin_25:
    ds_read_b32 v12, v4 offset:8
    s_add_u32 s97, s97, 1
    s_waitcnt lgkmcnt(0)
    v_readfirstlane_b32 s57, v12
    s_cmp_ge_u32 s97, 1048576
    s_nop 2
    s_cbranch_scc1 L_spd_26
    s_cmp_lt_u32 s57, 1
    s_cbranch_scc1 L_spin_25
L_spd_26:
    s_lshr_b32 s96, s57, 1
    s_waitcnt vmcnt(12)
    ds_read_b64_tr_b16 v[128:129], v10 offset:0
    ds_read_b64_tr_b16 v[130:131], v10 offset:128
    ds_read_b64_tr_b16 v[132:133], v11 offset:0
    ds_read_b64_tr_b16 v[134:135], v11 offset:128
    ds_read_b64_tr_b16 v[136:137], v10 offset:64
    ds_read_b64_tr_b16 v[138:139], v10 offset:192
    ds_read_b64_tr_b16 v[140:141], v11 offset:64
    ds_read_b64_tr_b16 v[142:143], v11 offset:192
    v_lshlrev_b32 v24, 16, v20
    v_and_b32 v25, s100, v20
    v_lshlrev_b32 v26, 16, v21
    v_and_b32 v27, s100, v21
    s_waitcnt vmcnt(8)
    ds_read_b64_tr_b16 v[144:145], v10 offset:1040
    ds_read_b64_tr_b16 v[146:147], v10 offset:1168
    ds_read_b64_tr_b16 v[148:149], v11 offset:1040
    ds_read_b64_tr_b16 v[150:151], v11 offset:1168
    ds_read_b64_tr_b16 v[152:153], v10 offset:1104
    ds_read_b64_tr_b16 v[154:155], v10 offset:1232
    ds_read_b64_tr_b16 v[156:157], v11 offset:1104
    ds_read_b64_tr_b16 v[158:159], v11 offset:1232
    s_waitcnt vmcnt(4)
    ds_read_b64_tr_b16 v[160:161], v10 offset:2080
    ds_read_b64_tr_b16 v[162:163], v10 offset:2208
    ds_read_b64_tr_b16 v[164:165], v11 offset:2080
    ds_read_b64_tr_b16 v[166:167], v11 offset:2208
    ds_read_b64_tr_b16 v[168:169], v10 offset:2144
    ds_read_b64_tr_b16 v[170:171], v10 offset:2272
    ds_read_b64_tr_b16 v[172:173], v11 offset:2144
    ds_read_b64_tr_b16 v[174:175], v11 offset:2272
    s_waitcnt vmcnt(0)
    s_mov_b32 s97, 0
    s_mov_b64 exec, 0xffff
    buffer_load_dwordx2 v[56:57], v14, s[36:39], s14 offen sc1
    s_mov_b64 exec, -1
    buffer_load_dwordx4 v[80:83], v13, s[36:39], s11 offen offset:0 sc1
    buffer_load_dwordx4 v[84:87], v13, s[36:39], s11 offen offset:64 sc1
    buffer_load_dwordx4 v[88:91], v13, s[36:39], s11 offen offset:128 sc1
    buffer_load_dwordx4 v[92:95], v13, s[36:39], s11 offen offset:192 sc1
    ds_read_b64_tr_b16 v[176:177], v10 offset:3120
    ds_read_b64_tr_b16 v[178:179], v10 offset:3248
    ds_read_b64_tr_b16 v[180:181], v11 offset:3120
    ds_read_b64_tr_b16 v[182:183], v11 offset:3248
    ds_read_b64_tr_b16 v[184:185], v10 offset:3184
    ds_read_b64_tr_b16 v[186:187], v10 offset:3312
    ds_read_b64_tr_b16 v[188:189], v11 offset:3184
    ds_read_b64_tr_b16 v[190:191], v11 offset:3312
    s_branch L_pchk_29
L_poll_27:
    s_mov_b64 exec, 0xffff
    buffer_load_dwordx2 v[56:57], v14, s[36:39], s14 offen sc1
    s_mov_b64 exec, -1
    buffer_load_dwordx4 v[80:83], v13, s[36:39], s11 offen offset:0 sc1
    buffer_load_dwordx4 v[84:87], v13, s[36:39], s11 offen offset:64 sc1
    buffer_load_dwordx4 v[88:91], v13, s[36:39], s11 offen offset:128 sc1
    buffer_load_dwordx4 v[92:95], v13, s[36:39], s11 offen offset:192 sc1
L_pchk_29:
    s_waitcnt vmcnt(4)
    v_max_u32 v8, v56, v57
    s_waitcnt vmcnt(3)
    v_max3_u32 v8, v80, v81, v8
    v_max3_u32 v8, v82, v83, v8
    s_waitcnt vmcnt(2)
    v_max3_u32 v8, v84, v85, v8
    v_max3_u32 v8, v86, v87, v8
    s_waitcnt vmcnt(1)
    v_max3_u32 v8, v88, v89, v8
    v_max3_u32 v8, v90, v91, v8
    s_waitcnt vmcnt(0)
    v_max3_u32 v8, v92, v93, v8
    v_max3_u32 v8, v94, v95, v8
    v_cmp_eq_u32 vcc, -1, v8
    s_nop 0
    s_cbranch_vccz L_pdone_28
    s_add_u32 s97, s97, 1
    s_cmp_lt_u32 s97, 131072
    s_cbranch_scc1 L_poll_27
L_pdone_28:
    s_waitcnt lgkmcnt(0)
    ds_bpermute_b32 v64, v54, v80
    ds_bpermute_b32 v65, v54, v81
    ds_bpermute_b32 v66, v54, v82
    ds_bpermute_b32 v67, v54, v83
    ds_bpermute_b32 v68, v54, v84
    ds_bpermute_b32 v69, v54, v85
    ds_bpermute_b32 v70, v54, v86
    ds_bpermute_b32 v71, v54, v87
    ds_bpermute_b32 v72, v54, v88
    ds_bpermute_b32 v73, v54, v89
    ds_bpermute_b32 v74, v54, v90
    ds_bpermute_b32 v75, v54, v91
    ds_bpermute_b32 v76, v54, v92
    ds_bpermute_b32 v77, v54, v93
    ds_bpermute_b32 v78, v54, v94
    ds_bpermute_b32 v79, v54, v95
    v_max_f32_dpp v30, v56, v56 row_ror:8 row_mask:0xf bank_mask:0xf
    s_mov_b32 s57, 0x3fb8aa3b
    v_sub_f32 v30, v56, v30
    v_mul_f32 v30, s57, v30
    v_exp_f32 v30, v30
    s_nop 0
    v_mul_f32 v30, v30, v57
    s_nop 1
    v_add_f32_dpp v31, v30, v30 row_ror:8 row_mask:0xf bank_mask:0xf
    v_rcp_f32 v31, v31
    s_nop 0
    v_mul_f32 v31, v30, v31
    ds_bpermute_b32 v30, v55, v31
    s_waitcnt lgkmcnt(13)
    v_mfma_f32_16x16x32_bf16 v[96:99], v[128:131], v[64:67], 0
    v_mfma_f32_16x16x32_bf16 v[100:103], v[132:135], v[64:67], 0
    v_mfma_f32_16x16x32_bf16 v[104:107], v[136:139], v[64:67], 0
    v_mfma_f32_16x16x32_bf16 v[108:111], v[140:143], v[64:67], 0
    s_waitcnt lgkmcnt(9)
    v_mfma_f32_16x16x32_bf16 v[96:99], v[144:147], v[68:71], v[96:99]
    v_mfma_f32_16x16x32_bf16 v[100:103], v[148:151], v[68:71], v[100:103]
    v_mfma_f32_16x16x32_bf16 v[104:107], v[152:155], v[68:71], v[104:107]
    v_mfma_f32_16x16x32_bf16 v[108:111], v[156:159], v[68:71], v[108:111]
    s_waitcnt lgkmcnt(5)
    v_mfma_f32_16x16x32_bf16 v[96:99], v[160:163], v[72:75], v[96:99]
    v_mfma_f32_16x16x32_bf16 v[100:103], v[164:167], v[72:75], v[100:103]
    v_mfma_f32_16x16x32_bf16 v[104:107], v[168:171], v[72:75], v[104:107]
    v_mfma_f32_16x16x32_bf16 v[108:111], v[172:175], v[72:75], v[108:111]
    s_waitcnt lgkmcnt(1)
    v_mfma_f32_16x16x32_bf16 v[96:99], v[176:179], v[76:79], v[96:99]
    v_mfma_f32_16x16x32_bf16 v[100:103], v[180:183], v[76:79], v[100:103]
    v_mfma_f32_16x16x32_bf16 v[104:107], v[184:187], v[76:79], v[104:107]
    v_mfma_f32_16x16x32_bf16 v[108:111], v[188:191], v[76:79], v[108:111]
    s_waitcnt lgkmcnt(0)
    s_nop 3
    v_pk_mul_f32 v[96:97], v[96:97], v[30:31] op_sel_hi:[1,0]
    v_pk_mul_f32 v[98:99], v[98:99], v[30:31] op_sel_hi:[1,0]
    v_pk_mul_f32 v[100:101], v[100:101], v[30:31] op_sel_hi:[1,0]
    v_pk_mul_f32 v[102:103], v[102:103], v[30:31] op_sel_hi:[1,0]
    v_pk_mul_f32 v[104:105], v[104:105], v[30:31] op_sel_hi:[1,0]
    v_pk_mul_f32 v[106:107], v[106:107], v[30:31] op_sel_hi:[1,0]
    v_pk_mul_f32 v[108:109], v[108:109], v[30:31] op_sel_hi:[1,0]
    v_pk_mul_f32 v[110:111], v[110:111], v[30:31] op_sel_hi:[1,0]
    v_add_f32_dpp v96, v96, v96 row_ror:8 row_mask:0xf bank_mask:0xf
    v_add_f32_dpp v97, v97, v97 row_ror:8 row_mask:0xf bank_mask:0xf
    v_add_f32_dpp v98, v98, v98 row_ror:8 row_mask:0xf bank_mask:0xf
    v_add_f32_dpp v99, v99, v99 row_ror:8 row_mask:0xf bank_mask:0xf
    v_add_f32_dpp v100, v100, v100 row_ror:8 row_mask:0xf bank_mask:0xf
    v_add_f32_dpp v101, v101, v101 row_ror:8 row_mask:0xf bank_mask:0xf
    v_add_f32_dpp v102, v102, v102 row_ror:8 row_mask:0xf bank_mask:0xf
    v_add_f32_dpp v103, v103, v103 row_ror:8 row_mask:0xf bank_mask:0xf
    v_add_f32_dpp v104, v104, v104 row_ror:8 row_mask:0xf bank_mask:0xf
    v_add_f32_dpp v105, v105, v105 row_ror:8 row_mask:0xf bank_mask:0xf
    v_add_f32_dpp v106, v106, v106 row_ror:8 row_mask:0xf bank_mask:0xf
    v_add_f32_dpp v107, v107, v107 row_ror:8 row_mask:0xf bank_mask:0xf
    v_add_f32_dpp v108, v108, v108 row_ror:8 row_mask:0xf bank_mask:0xf
    v_add_f32_dpp v109, v109, v109 row_ror:8 row_mask:0xf bank_mask:0xf
    v_add_f32_dpp v110, v110, v110 row_ror:8 row_mask:0xf bank_mask:0xf
    v_add_f32_dpp v111, v111, v111 row_ror:8 row_mask:0xf bank_mask:0xf
    s_mov_b32 exec_lo, 0xff00ff
    s_mov_b32 exec_hi, 0xff00ff
    ds_write_b128 v15, v[96:99] offset:0
    ds_write_b128 v15, v[100:103] offset:64
    ds_write_b128 v15, v[104:107] offset:128
    ds_write_b128 v15, v[108:111] offset:192
    s_mov_b64 exec, -1
    s_waitcnt lgkmcnt(0)
    s_barrier
    ds_read_b128 v[32:35], v16
    ds_read_b128 v[36:39], v16 offset:2176
    s_waitcnt lgkmcnt(0)
    v_add_f32 v32, v32, v36
    v_add_f32 v33, v33, v37
    v_add_f32 v34, v34, v38
    v_add_f32 v35, v35, v39
    v_mov_b32 v36, v32
    v_mov_b32 v37, v33
    v_mov_b32 v38, v34
    v_mov_b32 v39, v35
    v_permlane32_swap_b32 v32, v36
    v_permlane32_swap_b32 v33, v37
    v_permlane32_swap_b32 v34, v38
    v_permlane32_swap_b32 v35, v39
    v_add_f32 v32, v32, v36
    v_add_f32 v33, v33, v37
    v_add_f32 v34, v34, v38
    v_add_f32 v35, v35, v39
    v_min_u32 v32, -2, v32
    v_min_u32 v33, -2, v33
    v_min_u32 v34, -2, v34
    v_min_u32 v35, -2, v35
    buffer_store_dwordx4 v[32:35], v18, s[36:39], s15 offen sc1
    s_mov_b32 s97, 0
    s_nop 0
L_poll_30:
    buffer_load_dwordx4 v[64:67], v48, s[36:39], s63 offen sc1
    buffer_load_dwordx4 v[68:71], v49, s[36:39], s63 offen sc1
    buffer_load_dwordx4 v[72:75], v50, s[36:39], s63 offen sc1
    buffer_load_dwordx4 v[76:79], v51, s[36:39], s63 offen sc1
L_pchk_32:
    s_waitcnt vmcnt(3)
    v_max_u32 v8, v64, v65
    v_max3_u32 v8, v66, v67, v8
    s_waitcnt vmcnt(2)
    v_max3_u32 v8, v68, v69, v8
    v_max3_u32 v8, v70, v71, v8
    s_waitcnt vmcnt(1)
    v_max3_u32 v8, v72, v73, v8
    v_max3_u32 v8, v74, v75, v8
    s_waitcnt vmcnt(0)
    v_max3_u32 v8, v76, v77, v8
    v_max3_u32 v8, v78, v79, v8
    v_cmp_eq_u32 vcc, -1, v8
    s_nop 0
    s_cbranch_vccz L_pdone_31
    s_add_u32 s97, s97, 1
    s_cmp_lt_u32 s97, 131072
    s_cbranch_scc1 L_poll_30
L_pdone_31:
    v_add_f32 v80, v64, v68
    v_add_f32 v81, v65, v69
    v_add_f32 v82, v66, v70
    v_add_f32 v83, v67, v71
    v_add_f32 v84, v72, v76
    v_add_f32 v85, v73, v77
    v_add_f32 v86, v74, v78
    v_add_f32 v87, v75, v79
    v_add_f32 v80, v80, v84
    v_add_f32 v81, v81, v85
    v_add_f32 v82, v82, v86
    v_add_f32 v83, v83, v87
    v_mov_b32 v84, v80
    v_mov_b32 v85, v81
    v_mov_b32 v86, v82
    v_mov_b32 v87, v83
    v_permlane32_swap_b32 v80, v84
    v_permlane32_swap_b32 v81, v85
    v_permlane32_swap_b32 v82, v86
    v_permlane32_swap_b32 v83, v87
    v_add_f32 v80, v80, v84
    v_add_f32 v81, v81, v85
    v_add_f32 v82, v82, v86
    v_add_f32 v83, v83, v87
    v_add_f32 v80, v80, v32
    v_add_f32 v81, v81, v33
    v_add_f32 v82, v82, v34
    v_add_f32 v83, v83, v35
    v_cvt_pk_bf16_f32 v84, v80, v81
    v_cvt_pk_bf16_f32 v85, v82, v83
    v_lshlrev_b32 v80, 16, v84
    v_and_b32 v81, s100, v84
    v_lshlrev_b32 v82, 16, v85
    v_and_b32 v83, s100, v85
    v_add_f32 v80, v80, v24
    v_add_f32 v81, v81, v25
    v_add_f32 v82, v82, v26
    v_add_f32 v83, v83, v27
    v_cvt_pk_bf16_f32 v84, v80, v81
    v_cvt_pk_bf16_f32 v85, v82, v83
    v_min_u32 v84, -2, v84
    v_min_u32 v85, -2, v85
    s_cmp_eq_u32 s96, 0
    s_cbranch_scc1 L_sg_33
    buffer_store_dwordx2 v[84:85], v22, s[36:39], s62 offen
    s_branch L_sd_34
L_sg_33:
    buffer_store_dwordx2 v[84:85], v22, s[36:39], s62 offen sc1
L_sd_34:
    s_barrier
    s_mov_b32 s40, s22
    s_mov_b32 s41, s23
    s_mov_b32 s42, 5308416
    s_mov_b32 s43, 0x20000
    s_mov_b32 m0, s7
    s_nop 0
    buffer_load_dwordx4 v41, s[40:43], s6 offen offset:0 nt lds
    s_add_u32 s7, s7, 1024
    s_add_u32 s6, s6, 9216
    s_mov_b32 m0, s7
    s_nop 0
    buffer_load_dwordx4 v40, s[40:43], s6 offen offset:0 nt lds
    s_add_u32 s7, s7, 1024
    s_add_u32 s6, s6, 9216
    s_mov_b32 m0, s7
    s_nop 0
    buffer_load_dwordx4 v41, s[40:43], s6 offen offset:0 nt lds
    s_add_u32 s7, s7, 1024
    s_add_u32 s6, s6, 9216
    s_mov_b32 m0, s7
    s_nop 0
    buffer_load_dwordx4 v40, s[40:43], s6 offen offset:0 nt lds
    s_add_u32 s7, s7, 1024
    s_add_u32 s6, s6, 9216
    s_mov_b32 m0, s7
    s_nop 0
    buffer_load_dwordx4 v41, s[40:43], s6 offen offset:0 nt lds
    s_add_u32 s7, s7, 1024
    s_add_u32 s6, s6, 9216
    s_mov_b32 m0, s7
    s_nop 0
    buffer_load_dwordx4 v40, s[40:43], s6 offen offset:0 nt lds
    s_add_u32 s7, s7, 1024
    s_add_u32 s6, s6, 9216
    s_mov_b32 m0, s7
    s_nop 0
    buffer_load_dwordx4 v41, s[40:43], s6 offen offset:0 nt lds
    s_add_u32 s7, s7, 1024
    s_add_u32 s6, s6, 9216
    s_mov_b32 m0, s7
    s_nop 0
    buffer_load_dwordx4 v40, s[40:43], s6 offen offset:0 nt lds
    s_add_u32 s7, s7, 1024
    s_add_u32 s6, s6, 9216
    s_mov_b32 m0, s7
    s_nop 0
    buffer_load_dwordx4 v41, s[40:43], s6 offen offset:0 nt lds
    s_add_u32 s7, s7, 1024
    s_add_u32 s6, s6, 9216
    s_waitcnt vmcnt(0)
    s_barrier
    ds_read_b64_tr_b16 v[176:177], v42 offset:0
    ds_read_b64_tr_b16 v[178:179], v42 offset:512
    ds_read_b64_tr_b16 v[180:181], v42 offset:4096
    ds_read_b64_tr_b16 v[182:183], v42 offset:4608
    ds_read_b64_tr_b16 v[184:185], v42 offset:8192
    ds_read_b64_tr_b16 v[186:187], v42 offset:8704
    ds_read_b64_tr_b16 v[188:189], v42 offset:12288
    ds_read_b64_tr_b16 v[190:191], v42 offset:12800
    ds_read_b64_tr_b16 v[192:193], v42 offset:16384
    ds_read_b64_tr_b16 v[194:195], v42 offset:16896
    ds_read_b64_tr_b16 v[196:197], v42 offset:20480
    ds_read_b64_tr_b16 v[198:199], v42 offset:20992
    ds_read_b64_tr_b16 v[200:201], v42 offset:24576
    ds_read_b64_tr_b16 v[202:203], v42 offset:25088
    ds_read_b64_tr_b16 v[204:205], v42 offset:28672
    ds_read_b64_tr_b16 v[206:207], v42 offset:29184
    ds_read_b64_tr_b16 v[208:209], v42 offset:32768
    ds_read_b64_tr_b16 v[210:211], v42 offset:33280
    s_mov_b32 s97, 0
L_poll_35:
    buffer_load_dwordx4 v[64:67], v43, s[36:39], s8 offen offset:0 sc1
    buffer_load_dwordx4 v[68:71], v43, s[36:39], s8 offen offset:512 sc1
    buffer_load_dwordx4 v[72:75], v43, s[36:39], s8 offen offset:1024 sc1
    buffer_load_dwordx4 v[76:79], v43, s[36:39], s8 offen offset:1536 sc1
    buffer_load_dwordx4 v[80:83], v58, s[36:39], s8 offen offset:2048 sc1
L_pchk_37:
    s_waitcnt vmcnt(4)
    v_max_u32 v19, v64, v65
    v_max3_u32 v19, v66, v67, v19
    s_waitcnt vmcnt(3)
    v_max3_u32 v19, v68, v69, v19
    v_max3_u32 v19, v70, v71, v19
    s_waitcnt vmcnt(2)
    v_max3_u32 v19, v72, v73, v19
    v_max3_u32 v19, v74, v75, v19
    s_waitcnt vmcnt(1)
    v_max3_u32 v19, v76, v77, v19
    v_max3_u32 v19, v78, v79, v19
    s_waitcnt vmcnt(0)
    v_max3_u32 v19, v80, v81, v19
    v_max3_u32 v19, v82, v83, v19
    v_cmp_eq_u32 vcc, -1, v19
    s_nop 0
    s_cbranch_vccz L_pdone_36
    s_add_u32 s97, s97, 1
    s_cmp_lt_u32 s97, 131072
    s_cbranch_scc1 L_poll_35
L_pdone_36:
    s_waitcnt lgkmcnt(0)
    v_mfma_f32_16x16x32_bf16 v[32:35], v[176:179], v[64:67], 0
    v_mfma_f32_16x16x32_bf16 v[100:103], v[196:199], v[64:67], 0
    v_mfma_f32_16x16x32_bf16 v[32:35], v[180:183], v[68:71], v[32:35]
    v_mfma_f32_16x16x32_bf16 v[100:103], v[200:203], v[68:71], v[100:103]
    v_mfma_f32_16x16x32_bf16 v[32:35], v[184:187], v[72:75], v[32:35]
    v_mfma_f32_16x16x32_bf16 v[100:103], v[204:207], v[72:75], v[100:103]
    v_mfma_f32_16x16x32_bf16 v[32:35], v[188:191], v[76:79], v[32:35]
    v_mfma_f32_16x16x32_bf16 v[100:103], v[208:211], v[76:79], v[100:103]
    v_mfma_f32_16x16x32_bf16 v[32:35], v[192:195], v[80:83], v[32:35]
    s_nop 7
    v_add_f32_dpp v32, v100, v32 row_ror:8 row_mask:0xf bank_mask:0xf
    v_add_f32_dpp v33, v101, v33 row_ror:8 row_mask:0xf bank_mask:0xf
    v_add_f32_dpp v34, v102, v34 row_ror:8 row_mask:0xf bank_mask:0xf
    v_add_f32_dpp v35, v103, v35 row_ror:8 row_mask:0xf bank_mask:0xf
    v_min_u32 v32, -2, v32
    v_min_u32 v33, -2, v33
    v_min_u32 v34, -2, v34
    v_min_u32 v35, -2, v35
    buffer_store_dwordx4 v[32:35], v44, s[36:39], s10 offen sc1
    s_nop 0
    s_branch L_fin
L_spare:
    s_sub_u32 s101, s51, 27
    s_lshl_b32 s101, s101, 1
    v_lshrrev_b32 v40, 3, v1
    v_mul_u32_u24 v40, 1152, v40
    v_bfe_u32 v41, v1, 4, 1
    v_lshlrev_b32 v41, 1, v41
    v_and_b32 v42, 7, v1
    v_xor_b32 v41, v41, v42
    s_and_b32 s57, s49, 1
    s_lshl_b32 s57, s57, 2
    v_xor_b32 v41, s57, v41
    v_xor_b32 v42, 4, v41
    v_lshl_add_u32 v41, v41, 4, v40
    v_lshl_add_u32 v40, v42, 4, v40
    v_bfe_u32 v43, v1, 2, 2
    v_lshl_add_u32 v43, v3, 3, v43
    v_lshlrev_b32 v42, 7, v43
    v_bfe_u32 v43, v1, 3, 2
    v_xor_b32 v43, s49, v43
    v_lshl_add_u32 v42, v43, 5, v42
    v_and_b32 v43, 3, v1
    v_lshl_add_u32 v42, v43, 3, v42
    v_add_u32 v42, 25600, v42
    v_and_b32 v44, 7, v1
    v_lshlrev_b32 v43, 4, v44
    v_lshl_add_u32 v43, v3, 7, v43
    v_mov_b32 v45, 0x7ffffff0
    v_cmp_gt_u32 vcc, 8, v2
    s_nop 1
    v_cndmask_b32 v58, v45, v43, vcc
    v_bfe_u32 v45, v1, 3, 1
    v_mul_u32_u24 v45, 2560, v45
    v_add_u32 v43, v43, v45
    v_lshlrev_b32 v44, 6, v44
    v_lshl_add_u32 v44, v3, 4, v44
    v_mov_b32 v45, 0x7ffffff0
    v_cmp_gt_u32 vcc, 8, v2
    s_nop 1
    v_cndmask_b32 v44, v45, v44, vcc
    s_mul_i32 s6, s50, 576
    s_mul_i32 s57, s49, 72
    s_add_u32 s6, s6, s57
    s_add_u32 s6, s6, 288
    s_mul_i32 s6, s6, 1152
    s_lshl_b32 s57, s101, 7
    s_add_u32 s6, s6, s57
    s_mul_i32 s7, s49, 9216
    s_add_u32 s7, s7, 25600
    s_mul_i32 s8, s50, 9216
    s_add_u32 s8, s8, 913920
    s_add_u32 s9, s8, 4096
    s_lshl_b32 s10, s101, 15
    s_lshl_b32 s57, s50, 10
    s_add_u32 s10, s10, s57
    s_lshl_b32 s57, s49, 13
    s_add_u32 s10, s10, s57
    s_add_u32 s10, s10, 1057280
    s_mov_b32 s97, 0
L_spin_38:
    ds_read_b32 v12, v4 offset:20
    s_add_u32 s97, s97, 1
    s_waitcnt lgkmcnt(0)
    v_readfirstlane_b32 s57, v12
    s_cmp_ge_u32 s97, 1048576
    s_nop 2
    s_cbranch_scc1 L_spd_39
    s_cmp_lt_u32 s57, 4
    s_cbranch_scc1 L_spin_38
L_spd_39:
    s_mov_b32 s32, s12
    s_mov_b32 s33, s13
    s_mov_b32 s34, 4718592
    s_mov_b32 s35, 0x20000
    s_sub_u32 s57, s51, 27
    s_lshl_b32 s57, s57, 2
    s_add_u32 s57, s57, s49
    s_mul_i32 s57, s57, 6656
    s_mul_i32 s56, s50, 589824
    s_add_u32 s56, s56, s57
    s_add_u32 s56, s56, 479232
    v_lshlrev_b32 v12, 4, v1
    buffer_load_dwordx4 v[248:251], v12, s[32:35], s56 offen offset:0
    buffer_load_dwordx4 v[248:251], v12, s[32:35], s56 offen offset:1024
    buffer_load_dwordx4 v[248:251], v12, s[32:35], s56 offen offset:2048
    buffer_load_dwordx4 v[248:251], v12, s[32:35], s56 offen offset:3072
    s_add_u32 s56, s56, 4096
    buffer_load_dwordx4 v[248:251], v12, s[32:35], s56 offen offset:0
    buffer_load_dwordx4 v[248:251], v12, s[32:35], s56 offen offset:1024
    s_mov_b32 exec_lo, 0xffffffff
    s_mov_b32 exec_hi, 0x0
    buffer_load_dwordx4 v[248:251], v12, s[32:35], s56 offen offset:2048
    s_mov_b64 exec, -1
    s_mov_b32 s97, 0
L_spin_40:
    ds_read_b32 v12, v4 offset:4
    s_add_u32 s97, s97, 1
    s_waitcnt lgkmcnt(0)
    v_readfirstlane_b32 s57, v12
    s_cmp_ge_u32 s97, 1048576
    s_nop 2
    s_cbranch_scc1 L_spd_41
    s_cmp_lt_u32 s57, 5
    s_cbranch_scc1 L_spin_40
L_spd_41:
    s_mov_b32 s96, 0
    s_mov_b32 s40, s22
    s_mov_b32 s41, s23
    s_mov_b32 s42, 5308416
    s_mov_b32 s43, 0x20000
    s_mov_b32 m0, s7
    s_nop 0
    buffer_load_dwordx4 v41, s[40:43], s6 offen offset:0 nt lds
    s_add_u32 s57, s7, 36736
    s_mov_b32 m0, s57
    s_nop 0
    buffer_load_dwordx4 v41, s[40:43], s6 offen offset:128 nt lds
    s_add_u32 s7, s7, 1024
    s_add_u32 s6, s6, 9216
    s_mov_b32 m0, s7
    s_nop 0
    buffer_load_dwordx4 v40, s[40:43], s6 offen offset:0 nt lds
    s_add_u32 s57, s7, 36736
    s_mov_b32 m0, s57
    s_nop 0
    buffer_load_dwordx4 v40, s[40:43], s6 offen offset:128 nt lds
    s_add_u32 s7, s7, 1024
    s_add_u32 s6, s6, 9216
    s_mov_b32 m0, s7
    s_nop 0
    buffer_load_dwordx4 v41, s[40:43], s6 offen offset:0 nt lds
    s_add_u32 s57, s7, 36736
    s_mov_b32 m0, s57
    s_nop 0
    buffer_load_dwordx4 v41, s[40:43], s6 offen offset:128 nt lds
    s_add_u32 s7, s7, 1024
    s_add_u32 s6, s6, 9216
    s_mov_b32 m0, s7
    s_nop 0
    buffer_load_dwordx4 v40, s[40:43], s6 offen offset:0 nt lds
    s_add_u32 s57, s7, 36736
    s_mov_b32 m0, s57
    s_nop 0
    buffer_load_dwordx4 v40, s[40:43], s6 offen offset:128 nt lds
    s_add_u32 s7, s7, 1024
    s_add_u32 s6, s6, 9216
    s_mov_b32 m0, s7
    s_nop 0
    buffer_load_dwordx4 v41, s[40:43], s6 offen offset:0 nt lds
    s_add_u32 s57, s7, 36736
    s_mov_b32 m0, s57
    s_nop 0
    buffer_load_dwordx4 v41, s[40:43], s6 offen offset:128 nt lds
    s_add_u32 s7, s7, 1024
    s_add_u32 s6, s6, 9216
    s_mov_b32 m0, s7
    s_nop 0
    buffer_load_dwordx4 v40, s[40:43], s6 offen offset:0 nt lds
    s_add_u32 s57, s7, 36736
    s_mov_b32 m0, s57
    s_nop 0
    buffer_load_dwordx4 v40, s[40:43], s6 offen offset:128 nt lds
    s_add_u32 s7, s7, 1024
    s_add_u32 s6, s6, 9216
    s_mov_b32 m0, s7
    s_nop 0
    buffer_load_dwordx4 v41, s[40:43], s6 offen offset:0 nt lds
    s_add_u32 s57, s7, 36736
    s_mov_b32 m0, s57
    s_nop 0
    buffer_load_dwordx4 v41, s[40:43], s6 offen offset:128 nt lds
    s_add_u32 s7, s7, 1024
    s_add_u32 s6, s6, 9216
    s_mov_b32 m0, s7
    s_nop 0
    buffer_load_dwordx4 v40, s[40:43], s6 offen offset:0 nt lds
    s_add_u32 s57, s7, 36736
    s_mov_b32 m0, s57
    s_nop 0
    buffer_load_dwordx4 v40, s[40:43], s6 offen offset:128 nt lds
    s_add_u32 s7, s7, 1024
    s_add_u32 s6, s6, 9216
    s_mov_b32 m0, s7
    s_nop 0
    buffer_load_dwordx4 v41, s[40:43], s6 offen offset:0 nt lds
    s_add_u32 s57, s7, 36736
    s_mov_b32 m0, s57
    s_nop 0
    buffer_load_dwordx4 v41, s[40:43], s6 offen offset:128 nt lds
    s_add_u32 s7, s7, 1024
    s_add_u32 s6, s6, 9216
    s_setprio 3
    s_mov_b32 s97, 0
L_spin_42:
    ds_read_b32 v12, v4 offset:8
    s_add_u32 s97, s97, 1
    s_waitcnt lgkmcnt(0)
    v_readfirstlane_b32 s57, v12
    s_cmp_ge_u32 s97, 1048576
    s_nop 2
    s_cbranch_scc1 L_spd_43
    s_cmp_lt_u32 s57, 1
    s_cbranch_scc1 L_spin_42
L_spd_43:
    s_lshr_b32 s96, s57, 1
    s_waitcnt vmcnt(0)
    s_barrier
    ds_read_b64_tr_b16 v[176:177], v42 offset:0
    ds_read_b64_tr_b16 v[178:179], v42 offset:512
    ds_read_b64_tr_b16 v[180:181], v42 offset:4096
    ds_read_b64_tr_b16 v[182:183], v42 offset:4608
    ds_read_b64_tr_b16 v[184:185], v42 offset:8192
    ds_read_b64_tr_b16 v[186:187], v42 offset:8704
    ds_read_b64_tr_b16 v[188:189], v42 offset:12288
    ds_read_b64_tr_b16 v[190:191], v42 offset:12800
    ds_read_b64_tr_b16 v[192:193], v42 offset:16384
    ds_read_b64_tr_b16 v[194:195], v42 offset:16896
    ds_read_b64_tr_b16 v[196:197], v42 offset:20480
    ds_read_b64_tr_b16 v[198:199], v42 offset:20992
    ds_read_b64_tr_b16 v[200:201], v42 offset:24576
    ds_read_b64_tr_b16 v[202:203], v42 offset:25088
    ds_read_b64_tr_b16 v[204:205], v42 offset:28672
    ds_read_b64_tr_b16 v[206:207], v42 offset:29184
    ds_read_b64_tr_b16 v[208:209], v42 offset:32768
    ds_read_b64_tr_b16 v[210:211], v42 offset:33280
    v_add_u32 v42, 36864, v42
    ds_read_b64_tr_b16 v[212:213], v42 offset:0
    ds_read_b64_tr_b16 v[214:215], v42 offset:512
    ds_read_b64_tr_b16 v[216:217], v42 offset:4096
    ds_read_b64_tr_b16 v[218:219], v42 offset:4608
    ds_read_b64_tr_b16 v[220:221], v42 offset:8192
    ds_read_b64_tr_b16 v[222:223], v42 offset:8704
    ds_read_b64_tr_b16 v[224:225], v42 offset:12288
    ds_read_b64_tr_b16 v[226:227], v42 offset:12800
    ds_read_b64_tr_b16 v[228:229], v42 offset:16384
    ds_read_b64_tr_b16 v[230:231], v42 offset:16896
    ds_read_b64_tr_b16 v[232:233], v42 offset:20480
    ds_read_b64_tr_b16 v[234:235], v42 offset:20992
    ds_read_b64_tr_b16 v[236:237], v42 offset:24576
    ds_read_b64_tr_b16 v[238:239], v42 offset:25088
    ds_read_b64_tr_b16 v[240:241], v42 offset:28672
    ds_read_b64_tr_b16 v[242:243], v42 offset:29184
    ds_read_b64_tr_b16 v[244:245], v42 offset:32768
    ds_read_b64_tr_b16 v[246:247], v42 offset:33280
    s_mov_b32 s97, 0
L_poll_44:
    buffer_load_dwordx4 v[64:67], v43, s[36:39], s8 offen offset:0 sc1
    buffer_load_dwordx4 v[68:71], v43, s[36:39], s8 offen offset:512 sc1
    buffer_load_dwordx4 v[72:75], v43, s[36:39], s8 offen offset:1024 sc1
    buffer_load_dwordx4 v[76:79], v43, s[36:39], s8 offen offset:1536 sc1
    buffer_load_dwordx4 v[80:83], v58, s[36:39], s8 offen offset:2048 sc1
L_pchk_46:
    s_waitcnt vmcnt(4)
    v_max_u32 v19, v64, v65
    v_max3_u32 v19, v66, v67, v19
    s_waitcnt vmcnt(3)
    v_max3_u32 v19, v68, v69, v19
    v_max3_u32 v19, v70, v71, v19
    s_waitcnt vmcnt(2)
    v_max3_u32 v19, v72, v73, v19
    v_max3_u32 v19, v74, v75, v19
    s_waitcnt vmcnt(1)
    v_max3_u32 v19, v76, v77, v19
    v_max3_u32 v19, v78, v79, v19
    s_waitcnt vmcnt(0)
    v_max3_u32 v19, v80, v81, v19
    v_max3_u32 v19, v82, v83, v19
    v_cmp_eq_u32 vcc, -1, v19
    s_nop 0
    s_cbranch_vccz L_pdone_45
    s_add_u32 s97, s97, 1
    s_cmp_lt_u32 s97, 131072
    s_cbranch_scc1 L_poll_44
L_pdone_45:
    s_waitcnt lgkmcnt(0)
    v_mfma_f32_16x16x32_bf16 v[32:35], v[176:179], v[64:67], 0
    v_mfma_f32_16x16x32_bf16 v[100:103], v[196:199], v[64:67], 0
    v_mfma_f32_16x16x32_bf16 v[36:39], v[212:215], v[64:67], 0
    v_mfma_f32_16x16x32_bf16 v[104:107], v[232:235], v[64:67], 0
    v_mfma_f32_16x16x32_bf16 v[32:35], v[180:183], v[68:71], v[32:35]
    v_mfma_f32_16x16x32_bf16 v[100:103], v[200:203], v[68:71], v[100:103]
    v_mfma_f32_16x16x32_bf16 v[36:39], v[216:219], v[68:71], v[36:39]
    v_mfma_f32_16x16x32_bf16 v[104:107], v[236:239], v[68:71], v[104:107]
    v_mfma_f32_16x16x32_bf16 v[32:35], v[184:187], v[72:75], v[32:35]
    v_mfma_f32_16x16x32_bf16 v[100:103], v[204:207], v[72:75], v[100:103]
    v_mfma_f32_16x16x32_bf16 v[36:39], v[220:223], v[72:75], v[36:39]
    v_mfma_f32_16x16x32_bf16 v[104:107], v[240:243], v[72:75], v[104:107]
    v_mfma_f32_16x16x32_bf16 v[32:35], v[188:191], v[76:79], v[32:35]
    v_mfma_f32_16x16x32_bf16 v[100:103], v[208:211], v[76:79], v[100:103]
    v_mfma_f32_16x16x32_bf16 v[36:39], v[224:227], v[76:79], v[36:39]
    v_mfma_f32_16x16x32_bf16 v[104:107], v[244:247], v[76:79], v[104:107]
    v_mfma_f32_16x16x32_bf16 v[32:35], v[192:195], v[80:83], v[32:35]
    v_mfma_f32_16x16x32_bf16 v[36:39], v[228:231], v[80:83], v[36:39]
    s_nop 6
    v_add_f32_dpp v32, v100, v32 row_ror:8 row_mask:0xf bank_mask:0xf
    v_add_f32_dpp v33, v101, v33 row_ror:8 row_mask:0xf bank_mask:0xf
    v_add_f32_dpp v34, v102, v34 row_ror:8 row_mask:0xf bank_mask:0xf
    v_add_f32_dpp v35, v103, v35 row_ror:8 row_mask:0xf bank_mask:0xf
    v_add_f32_dpp v36, v104, v36 row_ror:8 row_mask:0xf bank_mask:0xf
    v_add_f32_dpp v37, v105, v37 row_ror:8 row_mask:0xf bank_mask:0xf
    v_add_f32_dpp v38, v106, v38 row_ror:8 row_mask:0xf bank_mask:0xf
    v_add_f32_dpp v39, v107, v39 row_ror:8 row_mask:0xf bank_mask:0xf
    v_min_u32 v32, -2, v32
    v_min_u32 v33, -2, v33
    v_min_u32 v34, -2, v34
    v_min_u32 v35, -2, v35
    buffer_store_dwordx4 v[32:35], v44, s[36:39], s10 offen sc1
    v_min_u32 v36, -2, v36
    v_min_u32 v37, -2, v37
    v_min_u32 v38, -2, v38
    v_min_u32 v39, -2, v39
    s_add_u32 s10, s10, 32768
    buffer_store_dwordx4 v[36:39], v44, s[36:39], s10 offen sc1
    s_nop 0
    s_branch L_fin
L_ffn:
    s_mov_b32 s44, s16
    s_mov_b32 s45, s17
    s_mov_b32 s46, 1152
    s_mov_b32 s47, 0x20000
    v_and_b32 v8, 31, v1
    v_lshlrev_b32 v9, 2, v8
    v_lshlrev_b32 v8, 4, v8
    buffer_load_dwordx4 v[40:43], v8, s[44:47], 0 offen
    buffer_load_dwordx4 v[44:47], v8, s[44:47], 0 offen offset:512
    buffer_load_dword v48, v9, s[44:47], 0 offen offset:1024
    s_cmp_ge_u32 s51, 9
    s_cselect_b32 s40, s20, s18
    s_cselect_b32 s41, s21, s19
    s_cselect_b32 s4, 1, 0
    s_cselect_b32 s57, 9, 0
    s_mov_b32 s42, 5308416
    s_mov_b32 s43, 0x20000
    s_sub_u32 s101, s51, s57
    v_lshrrev_b32 v18, 3, v1
    v_mul_u32_u24 v18, 9216, v18
    v_bfe_u32 v8, v1, 4, 2
    v_lshlrev_b32 v8, 1, v8
    v_and_b32 v9, 7, v1
    v_xor_b32 v8, v8, v9
    v_lshl_add_u32 v18, v8, 4, v18
    v_lshrrev_b32 v7, 5, v1
    s_lshl_b32 s57, s49, 1
    v_add_u32 v7, s57, v7
    v_mul_u32_u24 v7, 1152, v7
    v_and_b32 v6, 31, v1
    v_lshl_add_u32 v7, v6, 2, v7
    v_mul_u32_u24 v6, 12, v6
    v_add_u32 v6, v6, v7
    v_lshrrev_b32 v10, 5, v1
    s_lshl_b32 s57, s49, 1
    v_add_u32 v10, s57, v10
    v_mul_u32_u24 v10, 1184, v10
    v_bfe_u32 v8, v1, 2, 3
    v_lshl_add_u32 v8, v8, 6, v10
    v_and_b32 v9, 1, v1
    v_lshl_add_u32 v8, v9, 5, v8
    v_lshl_add_u32 v10, v9, 2, v10
    v_bfe_u32 v9, v1, 1, 1
    v_lshl_add_u32 v8, v9, 3, v8
    v_bfe_u32 v9, v1, 1, 2
    v_lshl_add_u32 v10, v9, 4, v10
    v_bfe_u32 v9, v1, 3, 1
    v_lshl_add_u32 v10, v9, 3, v10
    v_bfe_u32 v9, v1, 4, 1
    v_lshl_add_u32 v9, v9, 6, v10
    s_mul_i32 s62, s50, 9216
    s_lshl_b32 s57, s101, 10
    s_add_u32 s63, s62, s57
    s_lshl_b32 s57, s49, 8
    s_add_u32 s63, s63, s57
    s_add_u32 s5, s63, 983040
    s_add_u32 s63, s63, 909312
    s_add_u32 s62, s62, 835584
    v_bfe_u32 v10, v1, 2, 2
    v_lshl_add_u32 v10, v3, 2, v10
    v_bfe_u32 v11, v10, 1, 2
    v_xor_b32 v11, s49, v11
    v_lshlrev_b32 v11, 5, v11
    v_lshl_add_u32 v10, v10, 7, v11
    v_and_b32 v11, 3, v1
    v_lshl_add_u32 v10, v11, 3, v10
    v_add_u32 v10, 25600, v10
    v_add_u32 v11, 36864, v10
    v_and_b32 v13, 7, v1
    v_mul_u32_u24 v14, 1184, v13
    v_lshl_add_u32 v14, v3, 4, v14
    v_lshlrev_b32 v15, 4, v13
    v_bfe_u32 v16, v1, 5, 1
    v_lshl_add_u32 v15, v16, 7, v15
    v_bfe_u32 v16, v1, 4, 1
    v_lshl_add_u32 v15, v16, 3, v15
    v_mov_b32 v17, 0x7ffffff0
    v_cmp_gt_u32 vcc, 8, v2
    s_nop 1
    v_cndmask_b32 v15, v17, v15, vcc
    s_lshl_b32 s61, s51, 14
    s_lshl_b32 s57, s50, 6
    s_add_u32 s61, s61, s57
    s_add_u32 s61, s61, 1056768
    s_add_u32 s6, s61, 4096
    s_mul_i32 s57, s50, 9
    s_add_u32 s57, s57, s101
    s_lshl_b32 s57, s57, 7
    s_mul_i32 s58, s49, 1327104
    s_add_u32 s58, s58, s57
    s_mul_i32 s59, s49, 18432
    s_add_u32 s59, s59, 25600
    s_mov_b32 s97, 0
L_spin_47:
    ds_read_b32 v12, v4 offset:20
    s_add_u32 s97, s97, 1
    s_waitcnt lgkmcnt(0)
    v_readfirstlane_b32 s57, v12
    s_cmp_ge_u32 s97, 1048576
    s_nop 2
    s_cbranch_scc1 L_spd_48
    s_cmp_lt_u32 s57, 4
    s_cbranch_scc1 L_spin_47
L_spd_48:
    s_mov_b32 s32, s12
    s_mov_b32 s33, s13
    s_mov_b32 s34, 4718592
    s_mov_b32 s35, 0x20000
    s_mov_b32 s57, s51
    s_lshl_b32 s57, s57, 2
    s_add_u32 s57, s57, s49
    s_mul_i32 s57, s57, 6656
    s_mul_i32 s56, s50, 589824
    s_add_u32 s56, s56, s57
    s_add_u32 s56, s56, 0
    v_lshlrev_b32 v12, 4, v1
    buffer_load_dwordx4 v[248:251], v12, s[32:35], s56 offen offset:0
    buffer_load_dwordx4 v[248:251], v12, s[32:35], s56 offen offset:1024
    buffer_load_dwordx4 v[248:251], v12, s[32:35], s56 offen offset:2048
    buffer_load_dwordx4 v[248:251], v12, s[32:35], s56 offen offset:3072
    s_add_u32 s56, s56, 4096
    buffer_load_dwordx4 v[248:251], v12, s[32:35], s56 offen offset:0
    buffer_load_dwordx4 v[248:251], v12, s[32:35], s56 offen offset:1024
    s_mov_b32 exec_lo, 0xffffffff
    s_mov_b32 exec_hi, 0x0
    buffer_load_dwordx4 v[248:251], v12, s[32:35], s56 offen offset:2048
    s_mov_b64 exec, -1
    s_mov_b32 s96, 0
    s_mov_b32 s97, 0
L_spin_49:
    ds_read_b32 v12, v4 offset:4
    s_add_u32 s97, s97, 1
    s_waitcnt lgkmcnt(0)
    v_readfirstlane_b32 s57, v12
    s_cmp_ge_u32 s97, 1048576
    s_nop 2
    s_cbranch_scc1 L_spd_50
    s_cmp_lt_u32 s57, 5
    s_cbranch_scc1 L_spin_49
L_spd_50:
    s_mov_b32 m0, s59
    s_add_u32 s59, s59, 1024
    buffer_load_dwordx4 v18, s[40:43], s58 offen nt lds
    s_add_u32 s58, s58, 73728
    s_mov_b32 m0, s59
    s_add_u32 s59, s59, 1024
    buffer_load_dwordx4 v18, s[40:43], s58 offen nt lds
    s_add_u32 s58, s58, 73728
    s_mov_b32 m0, s59
    s_add_u32 s59, s59, 1024
    buffer_load_dwordx4 v18, s[40:43], s58 offen nt lds
    s_add_u32 s58, s58, 73728
    s_mov_b32 m0, s59
    s_add_u32 s59, s59, 1024
    buffer_load_dwordx4 v18, s[40:43], s58 offen nt lds
    s_add_u32 s58, s58, 73728
    s_mov_b32 m0, s59
    s_add_u32 s59, s59, 1024
    buffer_load_dwordx4 v18, s[40:43], s58 offen nt lds
    s_add_u32 s58, s58, 73728
    s_mov_b32 m0, s59
    s_add_u32 s59, s59, 1024
    buffer_load_dwordx4 v18, s[40:43], s58 offen nt lds
    s_add_u32 s58, s58, 73728
    s_mov_b32 m0, s59
    s_add_u32 s59, s59, 1024
    buffer_load_dwordx4 v18, s[40:43], s58 offen nt lds
    s_add_u32 s58, s58, 73728
    s_mov_b32 m0, s59
    s_add_u32 s59, s59, 1024
    buffer_load_dwordx4 v18, s[40:43], s58 offen nt lds
    s_add_u32 s58, s58, 73728
    s_mov_b32 m0, s59
    s_add_u32 s59, s59, 1024
    buffer_load_dwordx4 v18, s[40:43], s58 offen nt lds
    s_add_u32 s58, s58, 73728
    s_mov_b32 m0, s59
    s_add_u32 s59, s59, 1024
    buffer_load_dwordx4 v18, s[40:43], s58 offen nt lds
    s_add_u32 s58, s58, 73728
    s_mov_b32 m0, s59
    s_add_u32 s59, s59, 1024
    buffer_load_dwordx4 v18, s[40:43], s58 offen nt lds
    s_add_u32 s58, s58, 73728
    s_mov_b32 m0, s59
    s_add_u32 s59, s59, 1024
    buffer_load_dwordx4 v18, s[40:43], s58 offen nt lds
    s_add_u32 s58, s58, 73728
    s_mov_b32 m0, s59
    s_add_u32 s59, s59, 1024
    buffer_load_dwordx4 v18, s[40:43], s58 offen nt lds
    s_add_u32 s58, s58, 73728
    s_mov_b32 m0, s59
    s_add_u32 s59, s59, 1024
    buffer_load_dwordx4 v18, s[40:43], s58 offen nt lds
    s_add_u32 s58, s58, 73728
    s_mov_b32 m0, s59
    s_add_u32 s59, s59, 1024
    buffer_load_dwordx4 v18, s[40:43], s58 offen nt lds
    s_add_u32 s58, s58, 73728
    s_mov_b32 m0, s59
    s_add_u32 s59, s59, 1024
    buffer_load_dwordx4 v18, s[40:43], s58 offen nt lds
    s_add_u32 s58, s58, 73728
    s_mov_b32 m0, s59
    s_add_u32 s59, s59, 1024
    buffer_load_dwordx4 v18, s[40:43], s58 offen nt lds
    s_add_u32 s58, s58, 73728
    s_mov_b32 m0, s59
    s_add_u32 s59, s59, 1024
    buffer_load_dwordx4 v18, s[40:43], s58 offen nt lds
    s_add_u32 s58, s58, 73728
    s_setprio 3
    s_mov_b32 s44, s24
    s_mov_b32 s45, s25
    s_mov_b32 s46, 9216
    s_mov_b32 s47, 0x20000
    s_mov_b32 s97, 0
L_spin_51:
    ds_read_b32 v12, v4 offset:8
    s_add_u32 s97, s97, 1
    s_waitcnt lgkmcnt(0)
    v_readfirstlane_b32 s57, v12
    s_cmp_ge_u32 s97, 1048576
    s_nop 2
    s_cbranch_scc1 L_spd_52
    s_cmp_lt_u32 s57, 1
    s_cbranch_scc1 L_spin_51
L_spd_52:
    s_lshr_b32 s96, s57, 1
    s_waitcnt vmcnt(0)
    s_mov_b32 s97, 0
    buffer_load_dwordx4 v[20:23], v6, s[36:39], s62 offen sc1
    buffer_load_dwordx4 v[24:27], v6, s[36:39], s62 offen offset:512 sc1
    buffer_load_dword v28, v7, s[36:39], s62 offen offset:1024 sc1
    s_barrier
    ds_read_b64_tr_b16 v[128:129], v10 offset:0
    ds_read_b64_tr_b16 v[130:131], v10 offset:2048
    ds_read_b64_tr_b16 v[132:133], v10 offset:4096
    ds_read_b64_tr_b16 v[134:135], v10 offset:6144
    ds_read_b64_tr_b16 v[136:137], v10 offset:8192
    ds_read_b64_tr_b16 v[138:139], v10 offset:10240
    ds_read_b64_tr_b16 v[140:141], v10 offset:12288
    ds_read_b64_tr_b16 v[142:143], v10 offset:14336
    ds_read_b64_tr_b16 v[144:145], v10 offset:16384
    ds_read_b64_tr_b16 v[146:147], v10 offset:18432
    ds_read_b64_tr_b16 v[148:149], v10 offset:20480
    ds_read_b64_tr_b16 v[150:151], v10 offset:22528
    ds_read_b64_tr_b16 v[152:153], v10 offset:24576
    ds_read_b64_tr_b16 v[154:155], v10 offset:26624
    ds_read_b64_tr_b16 v[156:157], v10 offset:28672
    ds_read_b64_tr_b16 v[158:159], v10 offset:30720
    ds_read_b64_tr_b16 v[160:161], v10 offset:32768
    ds_read_b64_tr_b16 v[162:163], v10 offset:34816
    ds_read_b64_tr_b16 v[164:165], v11 offset:0
    ds_read_b64_tr_b16 v[166:167], v11 offset:2048
    ds_read_b64_tr_b16 v[168:169], v11 offset:4096
    ds_read_b64_tr_b16 v[170:171], v11 offset:6144
    ds_read_b64_tr_b16 v[172:173], v11 offset:8192
    ds_read_b64_tr_b16 v[174:175], v11 offset:10240
    ds_read_b64_tr_b16 v[176:177], v11 offset:12288
    ds_read_b64_tr_b16 v[178:179], v11 offset:14336
    ds_read_b64_tr_b16 v[180:181], v11 offset:16384
    ds_read_b64_tr_b16 v[182:183], v11 offset:18432
    ds_read_b64_tr_b16 v[184:185], v11 offset:20480
    ds_read_b64_tr_b16 v[186:187], v11 offset:22528
    ds_read_b64_tr_b16 v[188:189], v11 offset:24576
    ds_read_b64_tr_b16 v[190:191], v11 offset:26624
    ds_read_b64_tr_b16 v[192:193], v11 offset:28672
    ds_read_b64_tr_b16 v[194:195], v11 offset:30720
    ds_read_b64_tr_b16 v[196:197], v11 offset:32768
    ds_read_b64_tr_b16 v[198:199], v11 offset:34816
    s_branch L_pchk_55
L_poll_53:
    buffer_load_dwordx4 v[20:23], v6, s[36:39], s62 offen sc1
    buffer_load_dwordx4 v[24:27], v6, s[36:39], s62 offen offset:512 sc1
    buffer_load_dword v28, v7, s[36:39], s62 offen offset:1024 sc1
L_pchk_55:
    s_waitcnt vmcnt(2)
    v_max_u32 v19, v20, v21
    v_max3_u32 v19, v22, v23, v19
    s_waitcnt vmcnt(1)
    v_max3_u32 v19, v24, v25, v19
    v_max3_u32 v19, v26, v27, v19
    s_waitcnt vmcnt(0)
    v_max_u32 v19, v28, v19
    v_cmp_eq_u32 vcc, -1, v19
    s_nop 0
    s_cbranch_vccz L_pdone_54
    s_add_u32 s97, s97, 1
    s_cmp_lt_u32 s97, 131072
    s_cbranch_scc1 L_poll_53
L_pdone_54:
    s_mov_b32 s57, 0x3f803f80
    v_dot2_f32_bf16 v30, v20, s57, 0
    v_dot2_f32_bf16 v32, v20, v20, 0
    v_dot2_f32_bf16 v30, v21, s57, v30
    v_dot2_f32_bf16 v32, v21, v21, v32
    v_dot2_f32_bf16 v30, v22, s57, v30
    v_dot2_f32_bf16 v32, v22, v22, v32
    v_dot2_f32_bf16 v30, v23, s57, v30
    v_dot2_f32_bf16 v32, v23, v23, v32
    v_dot2_f32_bf16 v30, v24, s57, v30
    v_dot2_f32_bf16 v32, v24, v24, v32
    v_dot2_f32_bf16 v30, v25, s57, v30
    v_dot2_f32_bf16 v32, v25, v25, v32
    v_dot2_f32_bf16 v30, v26, s57, v30
    v_dot2_f32_bf16 v32, v26, v26, v32
    v_dot2_f32_bf16 v30, v27, s57, v30
    v_dot2_f32_bf16 v32, v27, v27, v32
    v_dot2_f32_bf16 v30, v28, s57, v30
    v_dot2_f32_bf16 v32, v28, v28, v32
    v_lshlrev_b32 v64, 16, v20
    v_and_b32 v65, s100, v20
    v_lshlrev_b32 v66, 16, v21
    v_add_f32_dpp v30, v30, v30 row_ror:8 row_mask:0xf bank_mask:0xf
    v_add_f32_dpp v32, v32, v32 row_ror:8 row_mask:0xf bank_mask:0xf
    v_and_b32 v67, s100, v21
    v_lshlrev_b32 v68, 16, v22
    v_add_f32_dpp v30, v30, v30 row_ror:4 row_mask:0xf bank_mask:0xf
    v_add_f32_dpp v32, v32, v32 row_ror:4 row_mask:0xf bank_mask:0xf
    v_and_b32 v69, s100, v22
    v_lshlrev_b32 v70, 16, v23
    v_add_f32_dpp v30, v30, v30 row_ror:2 row_mask:0xf bank_mask:0xf
    v_add_f32_dpp v32, v32, v32 row_ror:2 row_mask:0xf bank_mask:0xf
    v_and_b32 v71, s100, v23
    v_lshlrev_b32 v72, 16, v24
    v_add_f32_dpp v30, v30, v30 row_ror:1 row_mask:0xf bank_mask:0xf
    v_add_f32_dpp v32, v32, v32 row_ror:1 row_mask:0xf bank_mask:0xf
    v_and_b32 v73, s100, v24
    v_lshlrev_b32 v74, 16, v25
    v_mov_b32 v31, v30
    v_mov_b32 v33, v32
    v_and_b32 v75, s100, v25
    v_permlane16_swap_b32 v30, v31
    v_permlane16_swap_b32 v32, v33
    v_add_f32 v30, v30, v31
    v_add_f32 v32, v32, v33
    v_mul_f32 v30, 0x3ae38e39, v30
    v_mul_f32 v32, 0x3ae38e39, v32
    v_lshlrev_b32 v76, 16, v26
    v_fma_f32 v32, -v30, v30, v32
    v_and_b32 v77, s100, v26
    v_max_f32 v32, 0, v32
    v_lshlrev_b32 v78, 16, v27
    v_cvt_pk_bf16_f32 v34, v30, v32
    v_and_b32 v79, s100, v27
    v_lshlrev_b32 v80, 16, v28
    v_and_b32 v81, s100, v28
    v_lshlrev_b32 v30, 16, v34
    v_and_b32 v32, s100, v34
    v_add_f32 v32, 0x3727c5ac, v32
    v_cvt_pk_bf16_f32 v32, v32, v32
    v_pk_add_f32 v[64:65], v[64:65], v[30:31] op_sel_hi:[1,0] neg_lo:[0,1] neg_hi:[0,1]
    v_lshlrev_b32 v32, 16, v32
    v_pk_add_f32 v[66:67], v[66:67], v[30:31] op_sel_hi:[1,0] neg_lo:[0,1] neg_hi:[0,1]
    v_sqrt_f32 v32, v32
    v_pk_add_f32 v[68:69], v[68:69], v[30:31] op_sel_hi:[1,0] neg_lo:[0,1] neg_hi:[0,1]
    v_pk_add_f32 v[70:71], v[70:71], v[30:31] op_sel_hi:[1,0] neg_lo:[0,1] neg_hi:[0,1]
    v_cvt_pk_bf16_f32 v32, v32, v32
    v_pk_add_f32 v[72:73], v[72:73], v[30:31] op_sel_hi:[1,0] neg_lo:[0,1] neg_hi:[0,1]
    v_lshlrev_b32 v32, 16, v32
    v_pk_add_f32 v[74:75], v[74:75], v[30:31] op_sel_hi:[1,0] neg_lo:[0,1] neg_hi:[0,1]
    v_rcp_f32 v32, v32
    v_pk_add_f32 v[76:77], v[76:77], v[30:31] op_sel_hi:[1,0] neg_lo:[0,1] neg_hi:[0,1]
    v_pk_add_f32 v[78:79], v[78:79], v[30:31] op_sel_hi:[1,0] neg_lo:[0,1] neg_hi:[0,1]
    v_pk_add_f32 v[80:81], v[80:81], v[30:31] op_sel_hi:[1,0] neg_lo:[0,1] neg_hi:[0,1]
    v_cvt_pk_bf16_f32 v52, v64, v65
    v_cvt_pk_bf16_f32 v53, v66, v67
    v_cvt_pk_bf16_f32 v54, v68, v69
    v_cvt_pk_bf16_f32 v55, v70, v71
    v_cvt_pk_bf16_f32 v56, v72, v73
    v_cvt_pk_bf16_f32 v57, v74, v75
    v_cvt_pk_bf16_f32 v58, v76, v77
    v_cvt_pk_bf16_f32 v59, v78, v79
    v_cvt_pk_bf16_f32 v60, v80, v81
    v_lshlrev_b32 v64, 16, v52
    v_and_b32 v65, s100, v52
    v_lshlrev_b32 v66, 16, v53
    v_and_b32 v67, s100, v53
    v_lshlrev_b32 v68, 16, v54
    v_and_b32 v69, s100, v54
    v_lshlrev_b32 v70, 16, v55
    v_and_b32 v71, s100, v55
    v_lshlrev_b32 v72, 16, v56
    v_and_b32 v73, s100, v56
    v_lshlrev_b32 v74, 16, v57
    v_and_b32 v75, s100, v57
    v_lshlrev_b32 v76, 16, v58
    v_and_b32 v77, s100, v58
    v_lshlrev_b32 v78, 16, v59
    v_and_b32 v79, s100, v59
    v_lshlrev_b32 v80, 16, v60
    v_and_b32 v81, s100, v60
    v_pk_mul_f32 v[64:65], v[64:65], v[32:33] op_sel_hi:[1,0]
    v_pk_mul_f32 v[66:67], v[66:67], v[32:33] op_sel_hi:[1,0]
    v_pk_mul_f32 v[68:69], v[68:69], v[32:33] op_sel_hi:[1,0]
    v_pk_mul_f32 v[70:71], v[70:71], v[32:33] op_sel_hi:[1,0]
    v_pk_mul_f32 v[72:73], v[72:73], v[32:33] op_sel_hi:[1,0]
    v_pk_mul_f32 v[74:75], v[74:75], v[32:33] op_sel_hi:[1,0]
    v_pk_mul_f32 v[76:77], v[76:77], v[32:33] op_sel_hi:[1,0]
    v_pk_mul_f32 v[78:79], v[78:79], v[32:33] op_sel_hi:[1,0]
    v_pk_mul_f32 v[80:81], v[80:81], v[32:33] op_sel_hi:[1,0]
    v_cvt_pk_bf16_f32 v52, v64, v65
    v_cvt_pk_bf16_f32 v53, v66, v67
    v_cvt_pk_bf16_f32 v54, v68, v69
    v_cvt_pk_bf16_f32 v55, v70, v71
    v_cvt_pk_bf16_f32 v56, v72, v73
    v_cvt_pk_bf16_f32 v57, v74, v75
    v_cvt_pk_bf16_f32 v58, v76, v77
    v_cvt_pk_bf16_f32 v59, v78, v79
    v_cvt_pk_bf16_f32 v60, v80, v81
    ds_write_b64 v8, v[52:53] offset:6400
    ds_write_b64 v8, v[54:55] offset:6416
    ds_write_b64 v8, v[56:57] offset:6912
    ds_write_b64 v8, v[58:59] offset:6928
    ds_write_b32 v9, v60 offset:7424
    s_waitcnt lgkmcnt(0)
    s_barrier
    ds_read_b128 v[64:67], v14 offset:6400
    ds_read_b128 v[68:71], v14 offset:6464
    ds_read_b128 v[72:75], v14 offset:6528
    ds_read_b128 v[76:79], v14 offset:6592
    ds_read_b128 v[80:83], v14 offset:6656
    ds_read_b128 v[84:87], v14 offset:6720
    ds_read_b128 v[88:91], v14 offset:6784
    s_waitcnt lgkmcnt(6)
    v_mfma_f32_16x16x32_bf16 v[32:35], v[128:131], v[64:67], 0
    ds_read_b128 v[92:95], v14 offset:6848
    s_waitcnt lgkmcnt(6)
    v_mfma_f32_16x16x32_bf16 v[32:35], v[132:135], v[68:71], v[32:35]
    ds_read_b128 v[96:99], v14 offset:6912
    s_waitcnt lgkmcnt(6)
    v_mfma_f32_16x16x32_bf16 v[32:35], v[136:139], v[72:75], v[32:35]
    ds_read_b128 v[100:103], v14 offset:6976
    s_waitcnt lgkmcnt(6)
    v_mfma_f32_16x16x32_bf16 v[32:35], v[140:143], v[76:79], v[32:35]
    ds_read_b128 v[104:107], v14 offset:7040
    s_waitcnt lgkmcnt(6)
    v_mfma_f32_16x16x32_bf16 v[32:35], v[144:147], v[80:83], v[32:35]
    ds_read_b128 v[108:111], v14 offset:7104
    s_waitcnt lgkmcnt(6)
    v_mfma_f32_16x16x32_bf16 v[32:35], v[148:151], v[84:87], v[32:35]
    ds_read_b128 v[112:115], v14 offset:7168
    s_waitcnt lgkmcnt(6)
    v_mfma_f32_16x16x32_bf16 v[32:35], v[152:155], v[88:91], v[32:35]
    ds_read_b128 v[116:119], v14 offset:7232
    s_waitcnt lgkmcnt(6)
    v_mfma_f32_16x16x32_bf16 v[32:35], v[156:159], v[92:95], v[32:35]
    ds_read_b128 v[120:123], v14 offset:7296
    s_waitcnt lgkmcnt(6)
    v_mfma_f32_16x16x32_bf16 v[32:35], v[160:163], v[96:99], v[32:35]
    ds_read_b128 v[124:127], v14 offset:7360
    s_waitcnt lgkmcnt(6)
    v_mfma_f32_16x16x32_bf16 v[32:35], v[164:167], v[100:103], v[32:35]
    ds_read_b128 v[200:203], v14 offset:7424
    s_waitcnt lgkmcnt(6)
    v_mfma_f32_16x16x32_bf16 v[32:35], v[168:171], v[104:107], v[32:35]
    ds_read_b128 v[204:207], v14 offset:7488
    s_waitcnt lgkmcnt(6)
    v_mfma_f32_16x16x32_bf16 v[32:35], v[172:175], v[108:111], v[32:35]
    s_waitcnt lgkmcnt(5)
    v_mfma_f32_16x16x32_bf16 v[32:35], v[176:179], v[112:115], v[32:35]
    s_waitcnt lgkmcnt(4)
    v_mfma_f32_16x16x32_bf16 v[32:35], v[180:183], v[116:119], v[32:35]
    s_waitcnt lgkmcnt(3)
    v_mfma_f32_16x16x32_bf16 v[32:35], v[184:187], v[120:123], v[32:35]
    s_waitcnt lgkmcnt(2)
    v_mfma_f32_16x16x32_bf16 v[32:35], v[188:191], v[124:127], v[32:35]
    s_waitcnt lgkmcnt(1)
    v_mfma_f32_16x16x32_bf16 v[32:35], v[192:195], v[200:203], v[32:35]
    s_waitcnt lgkmcnt(0)
    v_mfma_f32_16x16x32_bf16 v[32:35], v[196:199], v[204:207], v[32:35]
    s_mov_b32 s57, 0xbfb8aa3b
    s_nop 6
    v_cvt_pk_bf16_f32 v36, v32, v33
    v_cvt_pk_bf16_f32 v37, v34, v35
    s_cmp_eq_u32 s4, 0
    s_cbranch_scc1 L_gate
    v_min_u32 v36, -2, v36
    v_min_u32 v37, -2, v37
    s_cmp_eq_u32 s96, 0
    s_cbranch_scc1 L_sg_56
    buffer_store_dwordx2 v[36:37], v15, s[36:39], s5 offen
    s_branch L_sd_57
L_sg_56:
    buffer_store_dwordx2 v[36:37], v15, s[36:39], s5 offen sc1
L_sd_57:
    s_branch L_gu_done
L_gate:
    v_lshlrev_b32 v64, 16, v36
    v_and_b32 v65, s100, v36
    v_lshlrev_b32 v66, 16, v37
    v_and_b32 v67, s100, v37
    v_mul_f32 v68, s57, v64
    v_mul_f32 v69, s57, v65
    v_mul_f32 v70, s57, v66
    v_mul_f32 v71, s57, v67
    v_exp_f32 v68, v68
    v_exp_f32 v69, v69
    v_exp_f32 v70, v70
    v_exp_f32 v71, v71
    v_add_f32 v68, 1.0, v68
    v_add_f32 v69, 1.0, v69
    v_add_f32 v70, 1.0, v70
    v_add_f32 v71, 1.0, v71
    v_rcp_f32 v68, v68
    v_rcp_f32 v69, v69
    v_rcp_f32 v70, v70
    v_rcp_f32 v71, v71
    v_mul_f32 v64, v64, v68
    v_mul_f32 v65, v65, v69
    v_mul_f32 v66, v66, v70
    v_mul_f32 v67, v67, v71
    v_cvt_pk_bf16_f32 v36, v64, v65
    v_cvt_pk_bf16_f32 v37, v66, v67
    v_lshlrev_b32 v64, 16, v36
    v_and_b32 v65, s100, v36
    v_lshlrev_b32 v66, 16, v37
    v_and_b32 v67, s100, v37
    s_mov_b32 s97, 0
    s_nop 0
L_poll_58:
    buffer_load_dwordx2 v[76:77], v15, s[36:39], s5 offen sc1
L_pchk_60:
    s_waitcnt vmcnt(0)
    v_max_u32 v19, v76, v77
    v_cmp_eq_u32 vcc, -1, v19
    s_nop 0
    s_cbranch_vccz L_pdone_59
    s_add_u32 s97, s97, 1
    s_cmp_lt_u32 s97, 131072
    s_cbranch_scc1 L_poll_58
L_pdone_59:
    v_lshlrev_b32 v72, 16, v76
    v_and_b32 v73, s100, v76
    v_lshlrev_b32 v74, 16, v77
    v_and_b32 v75, s100, v77
    v_mul_f32 v64, v64, v72
    v_mul_f32 v65, v65, v73
    v_mul_f32 v66, v66, v74
    v_mul_f32 v67, v67, v75
    v_cvt_pk_bf16_f32 v36, v64, v65
    v_cvt_pk_bf16_f32 v37, v66, v67
    v_min_u32 v36, -2, v36
    v_min_u32 v37, -2, v37
    s_cmp_eq_u32 s96, 0
    s_cbranch_scc1 L_sg_61
    buffer_store_dwordx2 v[36:37], v15, s[36:39], s63 offen
    s_branch L_sd_62
L_sg_61:
    buffer_store_dwordx2 v[36:37], v15, s[36:39], s63 offen sc1
L_sd_62:
L_gu_done:
    s_lshr_b32 s58, s50, 1
    s_cmp_lg_u32 s49, s58
    s_cbranch_scc1 L_fin
    ds_write_b64 v8, v[20:21] offset:15872
    ds_write_b64 v8, v[22:23] offset:15888
    ds_write_b64 v8, v[24:25] offset:16384
    ds_write_b64 v8, v[26:27] offset:16400
    ds_write_b32 v9, v28 offset:16896
    v_dot2_f32_bf16 v36, v52, v40, 0
    v_dot2_f32_bf16 v36, v53, v41, v36
    v_dot2_f32_bf16 v36, v54, v42, v36
    v_dot2_f32_bf16 v36, v55, v43, v36
    v_dot2_f32_bf16 v36, v56, v44, v36
    v_dot2_f32_bf16 v36, v57, v45, v36
    v_dot2_f32_bf16 v36, v58, v46, v36
    v_dot2_f32_bf16 v36, v59, v47, v36
    v_dot2_f32_bf16 v36, v60, v48, v36
    s_nop 2
    v_add_f32_dpp v36, v36, v36 row_ror:8 row_mask:0xf bank_mask:0xf
    s_nop 1
    v_add_f32_dpp v36, v36, v36 row_ror:4 row_mask:0xf bank_mask:0xf
    s_nop 1
    v_add_f32_dpp v36, v36, v36 row_ror:2 row_mask:0xf bank_mask:0xf
    s_nop 1
    v_add_f32_dpp v36, v36, v36 row_ror:1 row_mask:0xf bank_mask:0xf
    v_mov_b32 v37, v36
    s_nop 1
    v_permlane16_swap_b32 v36, v37
    v_add_f32 v36, v36, v37
    v_cvt_pk_bf16_f32 v36, v36, v36
    v_lshlrev_b32 v36, 16, v36
    v_mul_f32 v36, s57, v36
    v_exp_f32 v36, v36
    s_nop 0
    v_add_f32 v36, 1.0, v36
    v_rcp_f32 v36, v36
    s_nop 0
    v_cvt_pk_bf16_f32 v36, v36, v36
    v_lshlrev_b32 v36, 16, v36
    s_and_b32 s57, s50, 1
    s_lshl_b32 s57, s57, 5
    v_readlane_b32 s59, v36, s57
    v_lshrrev_b32 v6, 3, v1
    v_lshlrev_b32 v6, 9, v6
    v_and_b32 v7, 3, v1
    v_lshl_add_u32 v6, v7, 4, v6
    v_bfe_u32 v7, v1, 2, 1
    v_lshl_add_u32 v6, v7, 13, v6
    s_mul_i32 s57, s50, 1184
    s_lshl_b32 s58, s51, 6
    s_add_u32 s57, s57, s58
    v_and_b32 v7, 3, v1
    v_lshlrev_b32 v7, 4, v7
    v_bfe_u32 v8, v1, 2, 1
    v_lshl_add_u32 v7, v8, 3, v7
    v_add_u32 v7, s57, v7
    ds_read_b64 v[88:89], v7 offset:15872
    ds_read_b64 v[90:91], v7 offset:6400
    v_lshlrev_b32 v9, 3, v1
    v_mov_b32 v10, 0x7ffffff0
    v_cmp_gt_u32 vcc, 8, v1
    s_nop 1
    v_cndmask_b32 v9, v10, v9, vcc
    s_mul_i32 s58, s50, 1152
    s_lshl_b32 s57, s51, 6
    s_add_u32 s58, s58, s57
    s_waitcnt lgkmcnt(0)
    v_lshlrev_b32 v40, 16, v88
    v_and_b32 v41, s100, v88
    v_lshlrev_b32 v42, 16, v89
    v_and_b32 v43, s100, v89
    v_lshlrev_b32 v44, 16, v90
    v_and_b32 v45, s100, v90
    v_lshlrev_b32 v46, 16, v91
    v_and_b32 v47, s100, v91
    s_mov_b32 s97, 0
    s_nop 0
L_poll_63:
    buffer_load_dwordx4 v[80:83], v6, s[36:39], s61 offen sc1
    buffer_load_dwordx4 v[84:87], v6, s[36:39], s6 offen sc1
L_pchk_65:
    s_waitcnt vmcnt(1)
    v_max_u32 v19, v80, v81
    v_max3_u32 v19, v82, v83, v19
    s_waitcnt vmcnt(0)
    v_max3_u32 v19, v84, v85, v19
    v_max3_u32 v19, v86, v87, v19
    v_cmp_eq_u32 vcc, -1, v19
    s_nop 0
    s_cbranch_vccz L_pdone_64
    s_add_u32 s97, s97, 1
    s_cmp_lt_u32 s97, 131072
    s_cbranch_scc1 L_poll_63
L_pdone_64:
    v_add_f32 v32, v80, v84
    v_add_f32 v33, v81, v85
    v_add_f32 v34, v82, v86
    v_add_f32 v35, v83, v87
    v_add_f32_dpp v32, v32, v32 row_ror:8 row_mask:0xf bank_mask:0xf
    v_add_f32_dpp v33, v33, v33 row_ror:8 row_mask:0xf bank_mask:0xf
    v_add_f32_dpp v34, v34, v34 row_ror:8 row_mask:0xf bank_mask:0xf
    v_add_f32_dpp v35, v35, v35 row_ror:8 row_mask:0xf bank_mask:0xf
    v_mov_b32 v36, v32
    v_mov_b32 v37, v33
    v_mov_b32 v38, v34
    v_mov_b32 v39, v35
    v_permlane16_swap_b32 v32, v36
    v_permlane16_swap_b32 v33, v37
    v_permlane16_swap_b32 v34, v38
    v_permlane16_swap_b32 v35, v39
    v_add_f32 v32, v32, v36
    v_add_f32 v33, v33, v37
    v_add_f32 v34, v34, v38
    v_add_f32 v35, v35, v39
    v_mov_b32 v36, v32
    v_mov_b32 v37, v33
    v_mov_b32 v38, v34
    v_mov_b32 v39, v35
    v_permlane32_swap_b32 v32, v36
    v_permlane32_swap_b32 v33, v37
    v_permlane32_swap_b32 v34, v38
    v_permlane32_swap_b32 v35, v39
    v_add_f32 v32, v32, v36
    v_add_f32 v33, v33, v37
    v_add_f32 v34, v34, v38
    v_add_f32 v35, v35, v39
    v_cvt_pk_bf16_f32 v36, v32, v33
    v_cvt_pk_bf16_f32 v37, v34, v35
    v_lshlrev_b32 v32, 16, v36
    v_and_b32 v33, s100, v36
    v_lshlrev_b32 v34, 16, v37
    v_and_b32 v35, s100, v37
    v_mul_f32 v32, s59, v32
    v_mul_f32 v33, s59, v33
    v_mul_f32 v34, s59, v34
    v_mul_f32 v35, s59, v35
    v_cvt_pk_bf16_f32 v36, v32, v33
    v_cvt_pk_bf16_f32 v37, v34, v35
    v_lshlrev_b32 v32, 16, v36
    v_and_b32 v33, s100, v36
    v_lshlrev_b32 v34, 16, v37
    v_and_b32 v35, s100, v37
    v_fmac_f32 v32, 0, v44
    v_fmac_f32 v33, 0, v45
    v_fmac_f32 v34, 0, v46
    v_fmac_f32 v35, 0, v47
    v_add_f32 v32, v44, v32
    v_add_f32 v33, v45, v33
    v_add_f32 v34, v46, v34
    v_add_f32 v35, v47, v35
    v_cvt_pk_bf16_f32 v36, v32, v33
    v_cvt_pk_bf16_f32 v37, v34, v35
    v_lshlrev_b32 v32, 16, v36
    v_and_b32 v33, s100, v36
    v_lshlrev_b32 v34, 16, v37
    v_and_b32 v35, s100, v37
    v_add_f32 v32, v40, v32
    v_add_f32 v33, v41, v33
    v_add_f32 v34, v42, v34
    v_add_f32 v35, v43, v35
    v_cvt_pk_bf16_f32 v36, v32, v33
    v_cvt_pk_bf16_f32 v37, v34, v35
    buffer_store_dwordx2 v[36:37], v9, s[44:47], s58 offen
    s_cmp_lg_u32 s2, 0
    s_cbranch_scc1 L_fin
    v_mov_b32 v36, s30
    v_mov_b32 v37, s31
    v_mov_b32 v9, 0
    s_mov_b32 exec_lo, 0x1
    s_mov_b32 exec_hi, 0x0
    buffer_store_dwordx2 v[36:37], v9, s[36:39], 0 offen sc1
L_fin:
L_end:
    s_endpgm
.section .rodata,"a"
.p2align 6
.amdhsa_kernel sequential_preLN__sliding_block_cached__moe_arch_mod__decode_kernel
  .amdhsa_next_free_vgpr 256
  .amdhsa_next_free_sgpr 102
  .amdhsa_accum_offset 256
  .amdhsa_group_segment_fixed_size 0
  .amdhsa_kernarg_size 104
  .amdhsa_user_sgpr_count 2
  .amdhsa_user_sgpr_kernarg_segment_ptr 1
  .amdhsa_system_sgpr_workgroup_id_x 1
  .amdhsa_float_denorm_mode_32 3
.end_amdhsa_kernel
```
